```python
import torch

def _softmax(x, axis=-1):
    return torch.softmax(x, dim=axis)
def _gelu(x):
    return torch.nn.functional.gelu(x, approximate="tanh")
def _silu(x):
    return torch.nn.functional.silu(x)
def _sigmoid(x):
    return torch.sigmoid(x)
def _layernorm(x, axis=-1, eps=1e-5):
    m = x.mean(dim=axis, keepdim=True)
    v = x.var(dim=axis, keepdim=True, unbiased=False)
    return (x - m) / torch.sqrt(v + eps)
def _scatter_add(tgt, idx, src, axis=0):
    return tgt.clone().index_add_(axis, idx, src)
def _segment_sum(src, seg, n):
    out = torch.zeros((n,) + src.shape[1:], dtype=src.dtype)
    return out.index_add_(0, seg, src)
def _pad(x, pw):
    flat = tuple(v for pair in reversed(pw) for v in pair)
    return torch.nn.functional.pad(x, flat)

kernel_name = 'concat_heads__compressed_kv_cla__mha_block_cached__decode'

def setup_inputs():

    _w = (lambda a: (lambda t: t.to(torch.bfloat16) if t.is_floating_point() else t)(torch.as_tensor(a)))
    def _A_setup():
        B, H, Sq, Sk, D, M = 1, 32, 1, 4096, 128, 640
        Dc = 4 * D
        return {
            "x": _w((lambda *s: torch.randn(*s, dtype=torch.bfloat16) * 3.2)(B, Sq, M)),
            "c_kv": _w((lambda *s: torch.randn(*s, dtype=torch.bfloat16) * 0.1)(B, Sk, Dc)),
            "w_q": _w((lambda *s: torch.randn(*s, dtype=torch.bfloat16) * 6.4)(M, H, D) * (M ** -0.5)),
            "w_uk": _w((lambda *s: torch.randn(*s, dtype=torch.bfloat16) * 6.4)(Dc, H, D) * (Dc ** -0.5)),
            "w_uv": _w((lambda *s: torch.randn(*s, dtype=torch.bfloat16) * 0.1)(Dc, H, D) * (Dc ** -0.5)),
            "w_o": _w((lambda *s: torch.randn(*s, dtype=torch.bfloat16) * 0.1)(H, D, M) * ((H * D) ** -0.5)),
        }
    _A_in = _A_setup()

    def _B_setup():
        B, Sq, D = 1, 1, 640
        H, Sk, Dh = 32, 4096, 128
        return {
            "x": _w((lambda *s: torch.randn(*s, dtype=torch.bfloat16) * 1.6)(B, Sq, D)),
            "k_cache": _w((lambda *s: torch.randn(*s, dtype=torch.bfloat16) * 1.6)(B, H, Sk, Dh)),
            "v_cache": _w((lambda *s: torch.randn(*s, dtype=torch.bfloat16) * 0.05)(B, H, Sk, Dh)),
            "wq": _w((lambda *s: torch.randn(*s, dtype=torch.bfloat16) * 1.6)(D, H * Dh) * (D ** -0.5)),
            "wo": _w((lambda *s: torch.randn(*s, dtype=torch.bfloat16) * 0.05)(H * Dh, D) * ((H * Dh) ** -0.5)),
        }
    _B_in = _B_setup()

    return {
        "A_x": _A_in["x"],
        "A_c_kv": _A_in["c_kv"],
        "A_w_q": _A_in["w_q"],
        "A_w_uk": _A_in["w_uk"],
        "A_w_uv": _A_in["w_uv"],
        "A_w_o": _A_in["w_o"],
        "B_x": _B_in["x"],
        "B_k_cache": _B_in["k_cache"],
        "B_v_cache": _B_in["v_cache"],
        "B_wq": _B_in["wq"],
        "B_wo": _B_in["wo"],
    }

def reference(A_x, A_c_kv, A_w_q, A_w_uk, A_w_uv, A_w_o, B_x, B_k_cache, B_v_cache, B_wq, B_wo):
    def _A_ref(x, c_kv, w_q, w_uk, w_uv, w_o):
        B, Sq, M = x.shape[0], x.shape[1], x.shape[2]
        Sk = c_kv.shape[1]
        H, D = w_q.shape[1], w_q.shape[2]
        q = torch.einsum("bqm,mhd->bhqd", x, w_q)
        k = torch.einsum("bkc,chd->bhkd", c_kv, w_uk)
        v = torch.einsum("bkc,chd->bhkd", c_kv, w_uv)
        scores = torch.einsum("bhqd,bhkd->bhqk", q, k) * (D ** -0.5)
        off = Sk - Sq
        qi = torch.arange(Sq)[:, None]
        kj = torch.arange(Sk)[None, :]
        cmask = kj <= (qi + off)
        scores = torch.where(cmask[None, None], scores, -1e9)
        p = _softmax(scores, axis=-1)
        ctx = torch.einsum("bhqk,bhkd->bhqd", p, v)
        return torch.einsum("bhqd,hdm->bqm", ctx, w_o)

    def _B_ref(x, k_cache, v_cache, wq, wo):
        B, Sq, D = x.shape
        H, Dh = 32, 128
        q = (lambda x, *d: x.permute(*d))((x @ wq).reshape(B, Sq, H, Dh), 0, 2, 1, 3)
        scores = torch.einsum("bhqd,bhkd->bhqk", q, k_cache) * (Dh ** -0.5)
        p = _softmax(scores, axis=-1)
        o = torch.einsum("bhqk,bhkd->bhqd", p, v_cache)
        return (lambda x, *d: x.permute(*d))(o, 0, 2, 1, 3).reshape(B, Sq, H * Dh) @ wo

    a = _A_ref(A_x, A_c_kv, A_w_q, A_w_uk, A_w_uv, A_w_o)
    b = _B_ref(B_x, B_k_cache, B_v_cache, B_wq, B_wo)
    return torch.concatenate([a, b], axis=-1)
```

```asm
; @launch grid=(256,1,1) block=(512,1,1) lds=163840
.amdgcn_target "amdgcn-amd-amdhsa--gfx950"
.text
.globl concat_heads__compressed_kv_cla__mha_block_cached__decode_kernel
.p2align 8
.type concat_heads__compressed_kv_cla__mha_block_cached__decode_kernel,@function
concat_heads__compressed_kv_cla__mha_block_cached__decode_kernel:
s_cmp_ge_u32 s2, 256
s_cbranch_scc1 L_end
s_load_dwordx4 s[40:43], s[0:1], 96
s_load_dwordx16 s[16:31], s[0:1], 0
s_load_dwordx8 s[32:39], s[0:1], 64
v_lshrrev_b32 v2, 6, v0
v_and_b32 v1, 63, v0
v_readfirstlane_b32 s3, v2
s_and_b32 s6, s2, 7
s_lshr_b32 s7, s2, 3
s_mov_b32 s62, 0x07060501
s_mov_b32 s63, 0x07060502
s_mov_b32 s64, 0x07060503
s_mov_b32 s65, 0x0c04000c
s_mov_b32 s66, 0x01000100
s_mov_b32 s67, 0x03020302
s_mov_b32 s80, 0x3e0293ee
s_lshl_b32 s6, s6, 2
s_cmp_lt_u32 s7, 4
s_cbranch_scc1 L_PR
s_cmp_lt_u32 s7, 8
s_cbranch_scc1 L_Q
L_B:
s_cmp_eq_u32 s3, 7
s_cbranch_scc0 L_pf_1
s_getpc_b64 s[70:71]
L_pf_1_pc:
s_sub_u32 s70, s70, L_pf_1_pc-L_B
s_subb_u32 s71, s71, 0
v_lshlrev_b32 v254, 7, v1
v_min_u32 v254, L_PR-L_B-4, v254
global_load_dword v255, v254, s[70:71]
L_pf_1:
s_sub_u32 s7, s2, 64
s_mul_i32 s4, s7, 10923
s_lshr_b32 s4, s4, 16
s_mul_i32 s68, s4, 6
s_sub_u32 s5, s7, s68
v_lshlrev_b32 v2, 4, v1
v_lshrrev_b32 v248, 4, v1
v_and_b32 v249, 15, v1
v_lshlrev_b32 v39, 15, v248
v_lshl_add_u32 v39, v249, 4, v39
s_mul_i32 s68, s5, 7
s_add_u32 s68, s68, s3
s_cmp_lt_u32 s68, 40
s_cselect_b32 s69, 0, 0x7f000000
s_cmp_lt_u32 s3, 7
s_cselect_b32 s69, s69, 0x7f000000
s_cmp_eq_u32 s69, 0
s_cselect_b32 s68, s68, 0
v_or_b32 v39, s69, v39
s_lshl_b32 s74, s68, 5
v_lshl_add_u32 v38, v248, 3, s74
s_add_u32 s101, s4, s5
s_and_b32 s101, s101, 3
s_and_b32 s74, s4, 28
s_or_b32 s101, s101, s74
s_lshl_b32 s73, s68, 17
s_lshl_b32 s74, s101, 8
s_add_u32 s73, s73, s74
s_lshl_b32 s68, s5, 3
s_add_u32 s68, s68, s3
s_mul_i32 s70, s68, 18432
s_lshl_b32 s72, s4, 20
s_add_u32 s83, s72, 884736
s_add_u32 s72, s72, s70
s_lshl_b32 s82, s4, 7
s_add_u32 s82, s82, 761856
v_mov_b32 v218, 0
v_mov_b32 v217, 1
s_lshl_b32 s68, s3, 2
v_mov_b32 v253, s68
s_mov_b64 exec, 1
ds_write_b32 v253, v218 offset:12544
ds_write_b32 v218, v218 offset:12576
ds_write_b32 v253, v218 offset:12608
s_mov_b64 exec, -1
s_waitcnt lgkmcnt(0)
s_mov_b32 s52, s20
s_mov_b32 s53, s21
s_mov_b32 s54, 5242880
s_mov_b32 s55, 0x20000
s_mov_b32 s56, s34
s_mov_b32 s57, s35
s_mov_b32 s58, 5242880
s_mov_b32 s59, 0x20000
global_load_dwordx2 v[144:145], v38, s[16:17]
global_load_dwordx2 v[146:147], v38, s[28:29]
s_mov_b32 s44, s30
s_mov_b32 s45, s31
s_mov_b32 s46, 33554432
s_mov_b32 s47, 0x20000
s_mov_b32 s48, s32
s_mov_b32 s49, s33
s_mov_b32 s50, 33554432
s_mov_b32 s51, 0x20000
s_mov_b32 s75, s72
s_mov_b32 s69, s73
buffer_load_dwordx4 v[112:115], v39, s[52:55], s69 offen nt
s_add_u32 s69, s69, 8192
buffer_load_dwordx4 v[116:119], v39, s[52:55], s69 offen nt
s_add_u32 s69, s69, 8192
buffer_load_dwordx4 v[120:123], v39, s[52:55], s69 offen nt
s_add_u32 s69, s69, 8192
buffer_load_dwordx4 v[124:127], v39, s[52:55], s69 offen nt
s_barrier
s_load_dword s60, s[42:43], 0
s_mov_b32 s8, s42
s_mov_b32 s9, s43
s_mov_b32 s10, 3145728
s_mov_b32 s11, 0x20000
s_mov_b32 s12, s38
s_mov_b32 s13, s39
s_mov_b32 s14, 2560
s_mov_b32 s15, 0x20000
s_cmp_eq_u32 s3, 7
s_cbranch_scc0 L_bz_2
s_cmp_eq_u32 s5, 0
s_cbranch_scc0 L_bz_2
s_mov_b64 exec, 1
buffer_store_dword v217, v218, s[8:11], s82 offen sc1
s_mov_b64 exec, -1
s_waitcnt vmcnt(0)
L_bz_2:
v_and_b32 v248, 1, v1
v_lshlrev_b32 v248, 4, v248
v_mov_b32 v249, 0xffff
v_lshlrev_b32 v248, v248, v249
v_bfe_u32 v249, v1, 1, 2
v_cmp_eq_u32 vcc, 0, v249
s_nop 1
v_cndmask_b32 v4, 0, v248, vcc
v_cmp_eq_u32 vcc, 1, v249
s_nop 1
v_cndmask_b32 v5, 0, v248, vcc
v_cmp_eq_u32 vcc, 2, v249
s_nop 1
v_cndmask_b32 v6, 0, v248, vcc
v_cmp_eq_u32 vcc, 3, v249
s_nop 1
v_cndmask_b32 v7, 0, v248, vcc
v_and_b32 v248, 15, v1
v_bfe_u32 v249, v1, 4, 1
v_lshl_add_u32 v248, v248, 1, v249
v_lshlrev_b32 v248, 4, v248
s_lshl_b32 s68, s3, 9
v_add_u32 v38, s68, v248
s_waitcnt vmcnt(0)
v_perm_b32 v148, v144, v144, s66
v_perm_b32 v149, v144, v144, s67
v_perm_b32 v150, v145, v145, s66
v_perm_b32 v151, v145, v145, s67
v_and_b32 v16, v148, v4
v_and_b32 v17, v148, v5
v_and_b32 v18, v148, v6
v_and_b32 v19, v148, v7
v_and_b32 v20, v149, v4
v_and_b32 v21, v149, v5
v_and_b32 v22, v149, v6
v_and_b32 v23, v149, v7
v_mfma_f32_16x16x32_bf16 v[24:27], v[16:19], v[112:115], 0
v_and_b32 v16, v150, v4
v_and_b32 v17, v150, v5
v_and_b32 v18, v150, v6
v_and_b32 v19, v150, v7
v_mfma_f32_16x16x32_bf16 v[24:27], v[20:23], v[116:119], v[24:27]
v_and_b32 v20, v151, v4
v_and_b32 v21, v151, v5
v_and_b32 v22, v151, v6
v_and_b32 v23, v151, v7
v_mfma_f32_16x16x32_bf16 v[24:27], v[16:19], v[120:123], v[24:27]
s_nop 0
v_mfma_f32_16x16x32_bf16 v[24:27], v[20:23], v[124:127], v[24:27]
s_waitcnt lgkmcnt(0)
s_mul_i32 s61, s60, 0x9E3779B1
s_add_u32 s61, s61, 0x85EBCA6B
v_mov_b32 v37, s61
s_mov_b32 exec_hi, 0
s_nop 2
ds_write_b128 v38, v[24:27] offset:16384
s_mov_b32 exec_lo, 1
ds_write_b32 v253, v217 offset:12608
s_mov_b64 exec, -1
s_cmp_eq_u32 s3, 0
s_cbranch_scc0 L_b1_3
s_mov_b32 s81, 0
L_bf1_4:
ds_read_b128 v[180:183], v218 offset:12608
ds_read_b128 v[184:187], v218 offset:12624
s_waitcnt lgkmcnt(0)
v_cmp_ne_u32 s[6:7], 1, v180
v_cmp_ne_u32 vcc, 1, v181
s_or_b64 s[6:7], s[6:7], vcc
v_cmp_ne_u32 vcc, 1, v182
s_or_b64 s[6:7], s[6:7], vcc
v_cmp_ne_u32 vcc, 1, v183
s_or_b64 s[6:7], s[6:7], vcc
v_cmp_ne_u32 vcc, 1, v184
s_or_b64 s[6:7], s[6:7], vcc
v_cmp_ne_u32 vcc, 1, v185
s_or_b64 s[6:7], s[6:7], vcc
v_cmp_ne_u32 vcc, 1, v186
s_or_b64 s[6:7], s[6:7], vcc
v_cmp_ne_u32 vcc, 1, v187
s_or_b64 s[6:7], s[6:7], vcc
s_cmp_eq_u64 s[6:7], 0
s_cbranch_scc1 L_bf1_4_d
s_add_u32 s81, s81, 1
s_cmp_lt_u32 s81, 160000
s_cbranch_scc1 L_bf1_4
L_bf1_4_d:
v_and_b32 v248, 31, v1
v_lshlrev_b32 v248, 4, v248
ds_read_b128 v[148:151], v248 offset:16384
ds_read_b128 v[152:155], v248 offset:16896
ds_read_b128 v[156:159], v248 offset:17408
ds_read_b128 v[160:163], v248 offset:17920
ds_read_b128 v[164:167], v248 offset:18432
ds_read_b128 v[168:171], v248 offset:18944
ds_read_b128 v[172:175], v248 offset:19456
ds_read_b128 v[176:179], v248 offset:19968
s_mul_i32 s68, s101, 6
s_add_u32 s68, s68, s5
s_lshl_b32 s68, s68, 9
s_add_u32 s68, s68, 106496
s_waitcnt lgkmcnt(0)
v_pk_add_f32 v[148:149], v[148:149], v[152:153]
v_pk_add_f32 v[150:151], v[150:151], v[154:155]
v_pk_add_f32 v[156:157], v[156:157], v[160:161]
v_pk_add_f32 v[158:159], v[158:159], v[162:163]
v_pk_add_f32 v[164:165], v[164:165], v[168:169]
v_pk_add_f32 v[166:167], v[166:167], v[170:171]
v_pk_add_f32 v[172:173], v[172:173], v[176:177]
v_pk_add_f32 v[174:175], v[174:175], v[178:179]
v_pk_add_f32 v[148:149], v[148:149], v[156:157]
v_pk_add_f32 v[150:151], v[150:151], v[158:159]
v_pk_add_f32 v[164:165], v[164:165], v[172:173]
v_pk_add_f32 v[166:167], v[166:167], v[174:175]
v_pk_add_f32 v[148:149], v[148:149], v[164:165]
v_pk_add_f32 v[150:151], v[150:151], v[166:167]
v_perm_b32 v148, v148, v151, s62
v_perm_b32 v149, v149, v151, s63
v_perm_b32 v150, v150, v151, s64
v_mov_b32 v151, v37
s_mov_b32 exec_hi, 0
buffer_store_dwordx4 v[148:151], v248, s[8:11], s68 offen sc1
s_mov_b64 exec, -1
L_b1_3:
s_mov_b32 s69, s73
buffer_load_dwordx4 v[128:131], v39, s[56:59], s69 offen nt
s_add_u32 s69, s69, 8192
buffer_load_dwordx4 v[132:135], v39, s[56:59], s69 offen nt
s_add_u32 s69, s69, 8192
buffer_load_dwordx4 v[136:139], v39, s[56:59], s69 offen nt
s_add_u32 s69, s69, 8192
buffer_load_dwordx4 v[140:143], v39, s[56:59], s69 offen nt
buffer_load_dwordx4 v[40:43], v2, s[44:47], s75 offen offset:0 nt
buffer_load_dwordx4 v[44:47], v2, s[44:47], s75 offen offset:1024 nt
s_waitcnt vmcnt(2)
v_perm_b32 v148, v146, v146, s66
v_perm_b32 v149, v146, v146, s67
v_perm_b32 v150, v147, v147, s66
v_perm_b32 v151, v147, v147, s67
v_and_b32 v16, v148, v4
v_and_b32 v17, v148, v5
v_and_b32 v18, v148, v6
v_and_b32 v19, v148, v7
v_and_b32 v20, v149, v4
v_and_b32 v21, v149, v5
v_and_b32 v22, v149, v6
v_and_b32 v23, v149, v7
v_mfma_f32_16x16x32_bf16 v[12:15], v[16:19], v[128:131], 0
v_and_b32 v16, v150, v4
v_and_b32 v17, v150, v5
v_and_b32 v18, v150, v6
v_and_b32 v19, v150, v7
v_mfma_f32_16x16x32_bf16 v[12:15], v[20:23], v[132:135], v[12:15]
v_and_b32 v20, v151, v4
v_and_b32 v21, v151, v5
v_and_b32 v22, v151, v6
v_and_b32 v23, v151, v7
v_mfma_f32_16x16x32_bf16 v[12:15], v[16:19], v[136:139], v[12:15]
s_nop 0
v_mfma_f32_16x16x32_bf16 v[12:15], v[20:23], v[140:143], v[12:15]
s_mov_b32 exec_hi, 0
s_nop 6
ds_write_b128 v38, v[12:15] offset:0
s_mov_b32 exec_lo, 1
ds_write_b32 v253, v217 offset:12544
s_mov_b64 exec, -1
s_cmp_eq_u32 s3, 2
s_cbranch_scc0 L_b1_5
s_mov_b32 s81, 0
L_bf1_6:
ds_read_b128 v[180:183], v218 offset:12544
ds_read_b128 v[184:187], v218 offset:12560
s_waitcnt lgkmcnt(0)
v_cmp_ne_u32 s[6:7], 1, v180
v_cmp_ne_u32 vcc, 1, v181
s_or_b64 s[6:7], s[6:7], vcc
v_cmp_ne_u32 vcc, 1, v182
s_or_b64 s[6:7], s[6:7], vcc
v_cmp_ne_u32 vcc, 1, v183
s_or_b64 s[6:7], s[6:7], vcc
v_cmp_ne_u32 vcc, 1, v184
s_or_b64 s[6:7], s[6:7], vcc
v_cmp_ne_u32 vcc, 1, v185
s_or_b64 s[6:7], s[6:7], vcc
v_cmp_ne_u32 vcc, 1, v186
s_or_b64 s[6:7], s[6:7], vcc
v_cmp_ne_u32 vcc, 1, v187
s_or_b64 s[6:7], s[6:7], vcc
s_cmp_eq_u64 s[6:7], 0
s_cbranch_scc1 L_bf1_6_d
s_add_u32 s81, s81, 1
s_cmp_lt_u32 s81, 160000
s_cbranch_scc1 L_bf1_6
L_bf1_6_d:
v_and_b32 v248, 31, v1
v_lshlrev_b32 v248, 4, v248
ds_read_b128 v[148:151], v248 offset:0
ds_read_b128 v[152:155], v248 offset:512
ds_read_b128 v[156:159], v248 offset:1024
ds_read_b128 v[160:163], v248 offset:1536
ds_read_b128 v[164:167], v248 offset:2048
ds_read_b128 v[168:171], v248 offset:2560
ds_read_b128 v[172:175], v248 offset:3072
ds_read_b128 v[176:179], v248 offset:3584
s_mul_i32 s68, s101, 6
s_add_u32 s68, s68, s5
s_lshl_b32 s68, s68, 9
s_add_u32 s68, s68, 4096
s_waitcnt lgkmcnt(0)
v_pk_add_f32 v[148:149], v[148:149], v[152:153]
v_pk_add_f32 v[150:151], v[150:151], v[154:155]
v_pk_add_f32 v[156:157], v[156:157], v[160:161]
v_pk_add_f32 v[158:159], v[158:159], v[162:163]
v_pk_add_f32 v[164:165], v[164:165], v[168:169]
v_pk_add_f32 v[166:167], v[166:167], v[170:171]
v_pk_add_f32 v[172:173], v[172:173], v[176:177]
v_pk_add_f32 v[174:175], v[174:175], v[178:179]
v_pk_add_f32 v[148:149], v[148:149], v[156:157]
v_pk_add_f32 v[150:151], v[150:151], v[158:159]
v_pk_add_f32 v[164:165], v[164:165], v[172:173]
v_pk_add_f32 v[166:167], v[166:167], v[174:175]
v_pk_add_f32 v[148:149], v[148:149], v[164:165]
v_pk_add_f32 v[150:151], v[150:151], v[166:167]
v_perm_b32 v148, v148, v151, s62
v_perm_b32 v149, v149, v151, s63
v_perm_b32 v150, v150, v151, s64
v_mov_b32 v151, v37
s_mov_b32 exec_hi, 0
buffer_store_dwordx4 v[148:151], v248, s[8:11], s68 offen sc1
s_mov_b64 exec, -1
L_b1_5:
buffer_load_dwordx4 v[48:51], v2, s[44:47], s75 offen offset:2048 nt
buffer_load_dwordx4 v[52:55], v2, s[44:47], s75 offen offset:3072 nt
s_waitcnt vmcnt(3)
s_add_u32 s75, s75, 4096
buffer_load_dwordx4 v[56:59], v2, s[44:47], s75 offen offset:0 nt
s_waitcnt vmcnt(3)
buffer_load_dwordx4 v[60:63], v2, s[44:47], s75 offen offset:1024 nt
s_waitcnt vmcnt(3)
buffer_load_dwordx4 v[64:67], v2, s[44:47], s75 offen offset:2048 nt
s_waitcnt vmcnt(3)
buffer_load_dwordx4 v[68:71], v2, s[44:47], s75 offen offset:3072 nt
s_waitcnt vmcnt(3)
s_add_u32 s75, s75, 4096
buffer_load_dwordx4 v[72:75], v2, s[44:47], s75 offen offset:0 nt
s_waitcnt vmcnt(3)
buffer_load_dwordx4 v[76:79], v2, s[44:47], s75 offen offset:1024 nt
v_and_b32 v251, 31, v1
v_lshlrev_b32 v251, 4, v251
s_mul_i32 s76, s4, 3072
s_add_u32 s76, s76, 4096
s_cmp_eq_u32 s3, 1
s_cbranch_scc0 L_b2_7
buffer_load_dwordx4 v[148:151], v251, s[8:11], s76 offen offset:0 sc1
buffer_load_dwordx4 v[152:155], v251, s[8:11], s76 offen offset:512 sc1
buffer_load_dwordx4 v[156:159], v251, s[8:11], s76 offen offset:1024 sc1
buffer_load_dwordx4 v[160:163], v251, s[8:11], s76 offen offset:1536 sc1
buffer_load_dwordx4 v[164:167], v251, s[8:11], s76 offen offset:2048 sc1
buffer_load_dwordx4 v[168:171], v251, s[8:11], s76 offen offset:2560 sc1
L_b2_7:
s_waitcnt vmcnt(3)
buffer_load_dwordx4 v[80:83], v2, s[44:47], s75 offen offset:2048 nt
s_waitcnt vmcnt(3)
buffer_load_dwordx4 v[84:87], v2, s[44:47], s75 offen offset:3072 nt
s_waitcnt vmcnt(3)
s_add_u32 s75, s75, 4096
buffer_load_dwordx4 v[88:91], v2, s[44:47], s75 offen offset:0 nt
s_waitcnt vmcnt(3)
buffer_load_dwordx4 v[92:95], v2, s[44:47], s75 offen offset:1024 nt
s_waitcnt vmcnt(3)
buffer_load_dwordx4 v[96:99], v2, s[44:47], s75 offen offset:2048 nt
s_cmp_eq_u32 s3, 1
s_cbranch_scc0 L_b3_8
s_mov_b32 s81, 0
s_waitcnt vmcnt(5)
s_branch L_bq_9_c
L_bq_9:
buffer_load_dwordx4 v[148:151], v251, s[8:11], s76 offen offset:0 sc1
buffer_load_dwordx4 v[152:155], v251, s[8:11], s76 offen offset:512 sc1
buffer_load_dwordx4 v[156:159], v251, s[8:11], s76 offen offset:1024 sc1
buffer_load_dwordx4 v[160:163], v251, s[8:11], s76 offen offset:1536 sc1
buffer_load_dwordx4 v[164:167], v251, s[8:11], s76 offen offset:2048 sc1
buffer_load_dwordx4 v[168:171], v251, s[8:11], s76 offen offset:2560 sc1
s_waitcnt vmcnt(0)
L_bq_9_c:
v_cmp_ne_u32 s[6:7], s61, v151
v_cmp_ne_u32 vcc, s61, v155
s_or_b64 s[6:7], s[6:7], vcc
v_cmp_ne_u32 vcc, s61, v159
s_or_b64 s[6:7], s[6:7], vcc
v_cmp_ne_u32 vcc, s61, v163
s_or_b64 s[6:7], s[6:7], vcc
v_cmp_ne_u32 vcc, s61, v167
s_or_b64 s[6:7], s[6:7], vcc
v_cmp_ne_u32 vcc, s61, v171
s_or_b64 s[6:7], s[6:7], vcc
s_cmp_eq_u64 s[6:7], 0
s_cbranch_scc1 L_bq_9_d
s_add_u32 s81, s81, 1
s_cmp_lt_u32 s81, 20000
s_cbranch_scc0 L_bq_9_d
s_sleep 1
s_branch L_bq_9
L_bq_9_d:
v_perm_b32 v151, v149, v148, s65
v_lshl_or_b32 v151, v150, 24, v151
v_perm_b32 v155, v153, v152, s65
v_lshl_or_b32 v155, v154, 24, v155
v_perm_b32 v159, v157, v156, s65
v_lshl_or_b32 v159, v158, 24, v159
v_perm_b32 v163, v161, v160, s65
v_lshl_or_b32 v163, v162, 24, v163
v_perm_b32 v167, v165, v164, s65
v_lshl_or_b32 v167, v166, 24, v167
v_perm_b32 v171, v169, v168, s65
v_lshl_or_b32 v171, v170, 24, v171
v_pk_add_f32 v[148:149], v[148:149], v[152:153]
v_pk_add_f32 v[150:151], v[150:151], v[154:155]
v_pk_add_f32 v[156:157], v[156:157], v[160:161]
v_pk_add_f32 v[158:159], v[158:159], v[162:163]
v_pk_add_f32 v[164:165], v[164:165], v[168:169]
v_pk_add_f32 v[166:167], v[166:167], v[170:171]
v_pk_add_f32 v[148:149], v[148:149], v[156:157]
v_pk_add_f32 v[150:151], v[150:151], v[158:159]
v_pk_add_f32 v[148:149], v[148:149], v[164:165]
v_pk_add_f32 v[150:151], v[150:151], v[166:167]
v_cvt_pk_bf16_f32 v148, v148, v149
v_cvt_pk_bf16_f32 v149, v150, v151
v_lshrrev_b32 v251, 1, v251
s_mov_b32 exec_hi, 0
ds_write_b64 v251, v[148:149] offset:4096
s_mov_b32 exec_lo, 1
ds_write_b32 v218, v217 offset:12576
s_mov_b64 exec, -1
L_b3_8:
s_waitcnt vmcnt(3)
buffer_load_dwordx4 v[100:103], v2, s[44:47], s75 offen offset:3072 nt
s_waitcnt vmcnt(3)
s_add_u32 s75, s75, 4096
buffer_load_dwordx4 v[104:107], v2, s[44:47], s75 offen offset:0 nt
s_waitcnt vmcnt(3)
buffer_load_dwordx4 v[108:111], v2, s[44:47], s75 offen offset:1024 nt
s_barrier
s_mov_b32 s75, s72
s_waitcnt vmcnt(4)
buffer_load_dwordx4 v[112:115], v2, s[48:51], s75 offen offset:0 nt
s_waitcnt vmcnt(4)
buffer_load_dwordx4 v[116:119], v2, s[48:51], s75 offen offset:1024 nt
v_and_b32 v248, 15, v1
v_lshlrev_b32 v248, 4, v248
s_mov_b32 s81, 0
L_bq2_10:
ds_read_b32 v250, v218 offset:12576
ds_read_b128 v[8:11], v248 offset:4096
s_waitcnt lgkmcnt(0)
v_cmp_ne_u32 s[6:7], 1, v250
s_cmp_eq_u64 s[6:7], 0
s_cbranch_scc1 L_bq2_10_d
s_add_u32 s81, s81, 1
s_cmp_lt_u32 s81, 160000
s_cbranch_scc1 L_bq2_10
L_bq2_10_d:
v_dot2_f32_bf16 v24, v40, v8, 0
v_dot2_f32_bf16 v25, v44, v8, 0
v_dot2_f32_bf16 v26, v48, v8, 0
v_dot2_f32_bf16 v27, v52, v8, 0
v_dot2c_f32_bf16 v24, v41, v9
v_dot2c_f32_bf16 v25, v45, v9
v_dot2c_f32_bf16 v26, v49, v9
v_dot2c_f32_bf16 v27, v53, v9
v_dot2c_f32_bf16 v24, v42, v10
v_dot2c_f32_bf16 v25, v46, v10
v_dot2c_f32_bf16 v26, v50, v10
v_dot2c_f32_bf16 v27, v54, v10
v_dot2c_f32_bf16 v24, v43, v11
v_dot2c_f32_bf16 v25, v47, v11
v_dot2c_f32_bf16 v26, v51, v11
v_dot2c_f32_bf16 v27, v55, v11
v_add_f32_dpp v28, v24, v24 row_ror:8 row_mask:0xf bank_mask:0x3
v_add_f32_dpp v29, v25, v25 row_ror:8 row_mask:0xf bank_mask:0x3
s_nop 0
v_add_f32_dpp v28, v26, v26 row_ror:8 row_mask:0xf bank_mask:0xc
v_add_f32_dpp v29, v27, v27 row_ror:8 row_mask:0xf bank_mask:0xc
s_nop 0
v_add_f32_dpp v30, v28, v28 row_half_mirror row_mask:0xf bank_mask:0x5
s_nop 1
v_add_f32_dpp v30, v29, v29 row_half_mirror row_mask:0xf bank_mask:0xa
s_nop 1
v_add_f32_dpp v30, v30, v30 quad_perm:[2,3,0,1] row_mask:0xf bank_mask:0xf
s_nop 1
v_add_f32_dpp v30, v30, v30 quad_perm:[1,0,3,2] row_mask:0xf bank_mask:0xf
s_waitcnt vmcnt(4)
buffer_load_dwordx4 v[120:123], v2, s[48:51], s75 offen offset:2048 nt
s_waitcnt vmcnt(4)
buffer_load_dwordx4 v[124:127], v2, s[48:51], s75 offen offset:3072 nt
v_dot2_f32_bf16 v24, v56, v8, 0
v_dot2_f32_bf16 v25, v60, v8, 0
v_dot2_f32_bf16 v26, v64, v8, 0
v_dot2_f32_bf16 v27, v68, v8, 0
v_dot2c_f32_bf16 v24, v57, v9
v_dot2c_f32_bf16 v25, v61, v9
v_dot2c_f32_bf16 v26, v65, v9
v_dot2c_f32_bf16 v27, v69, v9
v_dot2c_f32_bf16 v24, v58, v10
v_dot2c_f32_bf16 v25, v62, v10
v_dot2c_f32_bf16 v26, v66, v10
v_dot2c_f32_bf16 v27, v70, v10
v_dot2c_f32_bf16 v24, v59, v11
v_dot2c_f32_bf16 v25, v63, v11
v_dot2c_f32_bf16 v26, v67, v11
v_dot2c_f32_bf16 v27, v71, v11
v_add_f32_dpp v28, v24, v24 row_ror:8 row_mask:0xf bank_mask:0x3
v_add_f32_dpp v29, v25, v25 row_ror:8 row_mask:0xf bank_mask:0x3
s_nop 0
v_add_f32_dpp v28, v26, v26 row_ror:8 row_mask:0xf bank_mask:0xc
v_add_f32_dpp v29, v27, v27 row_ror:8 row_mask:0xf bank_mask:0xc
s_nop 0
v_add_f32_dpp v31, v28, v28 row_half_mirror row_mask:0xf bank_mask:0x5
s_nop 1
v_add_f32_dpp v31, v29, v29 row_half_mirror row_mask:0xf bank_mask:0xa
s_nop 1
v_add_f32_dpp v31, v31, v31 quad_perm:[2,3,0,1] row_mask:0xf bank_mask:0xf
s_nop 1
v_add_f32_dpp v31, v31, v31 quad_perm:[1,0,3,2] row_mask:0xf bank_mask:0xf
s_waitcnt vmcnt(4)
s_add_u32 s75, s75, 4096
buffer_load_dwordx4 v[128:131], v2, s[48:51], s75 offen offset:0 nt
s_waitcnt vmcnt(4)
buffer_load_dwordx4 v[132:135], v2, s[48:51], s75 offen offset:1024 nt
v_dot2_f32_bf16 v24, v72, v8, 0
v_dot2_f32_bf16 v25, v76, v8, 0
v_dot2_f32_bf16 v26, v80, v8, 0
v_dot2_f32_bf16 v27, v84, v8, 0
v_dot2c_f32_bf16 v24, v73, v9
v_dot2c_f32_bf16 v25, v77, v9
v_dot2c_f32_bf16 v26, v81, v9
v_dot2c_f32_bf16 v27, v85, v9
v_dot2c_f32_bf16 v24, v74, v10
v_dot2c_f32_bf16 v25, v78, v10
v_dot2c_f32_bf16 v26, v82, v10
v_dot2c_f32_bf16 v27, v86, v10
v_dot2c_f32_bf16 v24, v75, v11
v_dot2c_f32_bf16 v25, v79, v11
v_dot2c_f32_bf16 v26, v83, v11
v_dot2c_f32_bf16 v27, v87, v11
v_add_f32_dpp v28, v24, v24 row_ror:8 row_mask:0xf bank_mask:0x3
v_add_f32_dpp v29, v25, v25 row_ror:8 row_mask:0xf bank_mask:0x3
s_nop 0
v_add_f32_dpp v28, v26, v26 row_ror:8 row_mask:0xf bank_mask:0xc
v_add_f32_dpp v29, v27, v27 row_ror:8 row_mask:0xf bank_mask:0xc
s_nop 0
v_add_f32_dpp v32, v28, v28 row_half_mirror row_mask:0xf bank_mask:0x5
s_nop 1
v_add_f32_dpp v32, v29, v29 row_half_mirror row_mask:0xf bank_mask:0xa
s_nop 1
v_add_f32_dpp v32, v32, v32 quad_perm:[2,3,0,1] row_mask:0xf bank_mask:0xf
s_nop 1
v_add_f32_dpp v32, v32, v32 quad_perm:[1,0,3,2] row_mask:0xf bank_mask:0xf
s_waitcnt vmcnt(4)
buffer_load_dwordx4 v[136:139], v2, s[48:51], s75 offen offset:2048 nt
s_waitcnt vmcnt(4)
buffer_load_dwordx4 v[140:143], v2, s[48:51], s75 offen offset:3072 nt
v_dot2_f32_bf16 v24, v88, v8, 0
v_dot2_f32_bf16 v25, v92, v8, 0
v_dot2_f32_bf16 v26, v96, v8, 0
v_dot2_f32_bf16 v27, v100, v8, 0
v_dot2c_f32_bf16 v24, v89, v9
v_dot2c_f32_bf16 v25, v93, v9
v_dot2c_f32_bf16 v26, v97, v9
v_dot2c_f32_bf16 v27, v101, v9
v_dot2c_f32_bf16 v24, v90, v10
v_dot2c_f32_bf16 v25, v94, v10
v_dot2c_f32_bf16 v26, v98, v10
v_dot2c_f32_bf16 v27, v102, v10
v_dot2c_f32_bf16 v24, v91, v11
v_dot2c_f32_bf16 v25, v95, v11
v_dot2c_f32_bf16 v26, v99, v11
v_dot2c_f32_bf16 v27, v103, v11
v_add_f32_dpp v28, v24, v24 row_ror:8 row_mask:0xf bank_mask:0x3
v_add_f32_dpp v29, v25, v25 row_ror:8 row_mask:0xf bank_mask:0x3
s_nop 0
v_add_f32_dpp v28, v26, v26 row_ror:8 row_mask:0xf bank_mask:0xc
v_add_f32_dpp v29, v27, v27 row_ror:8 row_mask:0xf bank_mask:0xc
s_nop 0
v_add_f32_dpp v33, v28, v28 row_half_mirror row_mask:0xf bank_mask:0x5
s_nop 1
v_add_f32_dpp v33, v29, v29 row_half_mirror row_mask:0xf bank_mask:0xa
s_nop 1
v_add_f32_dpp v33, v33, v33 quad_perm:[2,3,0,1] row_mask:0xf bank_mask:0xf
s_nop 1
v_add_f32_dpp v33, v33, v33 quad_perm:[1,0,3,2] row_mask:0xf bank_mask:0xf
s_waitcnt vmcnt(4)
s_add_u32 s75, s75, 4096
buffer_load_dwordx4 v[144:147], v2, s[48:51], s75 offen offset:0 nt
s_waitcnt vmcnt(4)
buffer_load_dwordx4 v[148:151], v2, s[48:51], s75 offen offset:1024 nt
v_dot2_f32_bf16 v24, v104, v8, 0
v_dot2_f32_bf16 v25, v108, v8, 0
s_nop 1
v_dot2c_f32_bf16 v24, v105, v9
v_dot2c_f32_bf16 v25, v109, v9
v_dot2c_f32_bf16 v24, v106, v10
v_dot2c_f32_bf16 v25, v110, v10
v_dot2c_f32_bf16 v24, v107, v11
v_dot2c_f32_bf16 v25, v111, v11
v_mov_b32 v28, 0xf149f2ca
v_mov_b32 v29, 0xf149f2ca
s_nop 0
v_add_f32_dpp v28, v24, v24 row_ror:8 row_mask:0xf bank_mask:0x3
v_add_f32_dpp v29, v25, v25 row_ror:8 row_mask:0xf bank_mask:0x3
s_nop 0
v_add_f32_dpp v34, v28, v28 row_half_mirror row_mask:0xf bank_mask:0x5
s_nop 1
v_add_f32_dpp v34, v29, v29 row_half_mirror row_mask:0xf bank_mask:0xa
s_nop 1
v_add_f32_dpp v34, v34, v34 quad_perm:[2,3,0,1] row_mask:0xf bank_mask:0xf
s_nop 1
v_add_f32_dpp v34, v34, v34 quad_perm:[1,0,3,2] row_mask:0xf bank_mask:0xf
v_max3_f32 v248, v30, v31, v32
v_max3_f32 v248, v248, v33, v34
s_nop 1
v_max_f32_dpp v248, v248, v248 row_ror:4 row_mask:0xf bank_mask:0xf
s_nop 1
v_max_f32_dpp v248, v248, v248 row_ror:8 row_mask:0xf bank_mask:0xf
v_mov_b32 v250, v248
s_nop 1
v_permlane16_swap_b32 v248, v250
v_max_f32 v248, v248, v250
v_mov_b32 v250, v248
s_nop 1
v_permlane32_swap_b32 v248, v250
v_max_f32 v248, v248, v250
v_mul_f32 v248, s80, v248
v_fma_f32 v30, v30, s80, -v248
v_fma_f32 v31, v31, s80, -v248
v_fma_f32 v32, v32, s80, -v248
v_fma_f32 v33, v33, s80, -v248
v_fma_f32 v34, v34, s80, -v248
v_exp_f32 v30, v30
v_exp_f32 v31, v31
v_exp_f32 v32, v32
v_exp_f32 v33, v33
v_exp_f32 v34, v34
v_add_f32 v249, v30, v31
v_add_f32 v249, v249, v32
v_add_f32 v249, v249, v33
v_add_f32 v249, v249, v34
v_cvt_pk_bf16_f32 v30, v30, v30
v_cvt_pk_bf16_f32 v31, v31, v31
v_cvt_pk_bf16_f32 v32, v32, v32
v_cvt_pk_bf16_f32 v33, v33, v33
v_cvt_pk_bf16_f32 v34, v34, v34
v_add_f32_dpp v249, v249, v249 row_ror:4 row_mask:0xf bank_mask:0xf
s_nop 1
v_add_f32_dpp v249, v249, v249 row_ror:8 row_mask:0xf bank_mask:0xf
v_mov_b32 v250, v249
s_nop 1
v_permlane16_swap_b32 v249, v250
v_add_f32 v249, v249, v250
v_mov_b32 v250, v249
s_nop 1
v_permlane32_swap_b32 v249, v250
v_add_f32 v249, v249, v250
v_and_b32_dpp v16, v30, v4 row_newbcast:0 row_mask:0xf bank_mask:0xf
v_and_b32_dpp v17, v30, v5 row_newbcast:0 row_mask:0xf bank_mask:0xf
v_and_b32_dpp v18, v30, v6 row_newbcast:0 row_mask:0xf bank_mask:0xf
v_and_b32_dpp v19, v30, v7 row_newbcast:0 row_mask:0xf bank_mask:0xf
s_waitcnt vmcnt(4)
buffer_load_dwordx4 v[152:155], v2, s[48:51], s75 offen offset:2048 nt
s_cmp_eq_u32 s3, 7
s_cbranch_scc0 L_pf_11
s_getpc_b64 s[70:71]
L_pf_11_pc:
s_add_u32 s70, s70, L_B_t-L_pf_11_pc
s_addc_u32 s71, s71, 0
v_lshlrev_b32 v254, 7, v1
v_min_u32 v254, L_PR-L_B_t-4, v254
global_load_dword v255, v254, s[70:71]
L_pf_11:
v_and_b32_dpp v20, v30, v4 row_newbcast:4 row_mask:0xf bank_mask:0xf
v_and_b32_dpp v21, v30, v5 row_newbcast:4 row_mask:0xf bank_mask:0xf
v_and_b32_dpp v22, v30, v6 row_newbcast:4 row_mask:0xf bank_mask:0xf
v_and_b32_dpp v23, v30, v7 row_newbcast:4 row_mask:0xf bank_mask:0xf
v_mfma_f32_16x16x32_bf16 v[12:15], v[16:19], v[112:115], 0
v_and_b32_dpp v16, v30, v4 row_newbcast:8 row_mask:0xf bank_mask:0xf
v_and_b32_dpp v17, v30, v5 row_newbcast:8 row_mask:0xf bank_mask:0xf
v_and_b32_dpp v18, v30, v6 row_newbcast:8 row_mask:0xf bank_mask:0xf
v_and_b32_dpp v19, v30, v7 row_newbcast:8 row_mask:0xf bank_mask:0xf
v_mfma_f32_16x16x32_bf16 v[12:15], v[20:23], v[116:119], v[12:15]
s_waitcnt vmcnt(4)
buffer_load_dwordx4 v[156:159], v2, s[48:51], s75 offen offset:3072 nt
v_and_b32_dpp v20, v30, v4 row_newbcast:12 row_mask:0xf bank_mask:0xf
v_and_b32_dpp v21, v30, v5 row_newbcast:12 row_mask:0xf bank_mask:0xf
v_and_b32_dpp v22, v30, v6 row_newbcast:12 row_mask:0xf bank_mask:0xf
v_and_b32_dpp v23, v30, v7 row_newbcast:12 row_mask:0xf bank_mask:0xf
v_mfma_f32_16x16x32_bf16 v[12:15], v[16:19], v[120:123], v[12:15]
v_and_b32_dpp v16, v31, v4 row_newbcast:0 row_mask:0xf bank_mask:0xf
v_and_b32_dpp v17, v31, v5 row_newbcast:0 row_mask:0xf bank_mask:0xf
v_and_b32_dpp v18, v31, v6 row_newbcast:0 row_mask:0xf bank_mask:0xf
v_and_b32_dpp v19, v31, v7 row_newbcast:0 row_mask:0xf bank_mask:0xf
v_mfma_f32_16x16x32_bf16 v[12:15], v[20:23], v[124:127], v[12:15]
s_waitcnt vmcnt(4)
s_add_u32 s75, s75, 4096
buffer_load_dwordx4 v[160:163], v2, s[48:51], s75 offen offset:0 nt
v_and_b32_dpp v20, v31, v4 row_newbcast:4 row_mask:0xf bank_mask:0xf
v_and_b32_dpp v21, v31, v5 row_newbcast:4 row_mask:0xf bank_mask:0xf
v_and_b32_dpp v22, v31, v6 row_newbcast:4 row_mask:0xf bank_mask:0xf
v_and_b32_dpp v23, v31, v7 row_newbcast:4 row_mask:0xf bank_mask:0xf
v_mfma_f32_16x16x32_bf16 v[12:15], v[16:19], v[128:131], v[12:15]
v_and_b32_dpp v16, v31, v4 row_newbcast:8 row_mask:0xf bank_mask:0xf
v_and_b32_dpp v17, v31, v5 row_newbcast:8 row_mask:0xf bank_mask:0xf
v_and_b32_dpp v18, v31, v6 row_newbcast:8 row_mask:0xf bank_mask:0xf
v_and_b32_dpp v19, v31, v7 row_newbcast:8 row_mask:0xf bank_mask:0xf
v_mfma_f32_16x16x32_bf16 v[12:15], v[20:23], v[132:135], v[12:15]
s_waitcnt vmcnt(4)
buffer_load_dwordx4 v[164:167], v2, s[48:51], s75 offen offset:1024 nt
s_barrier
v_mov_b32 v216, 2
s_mov_b64 exec, 1
buffer_atomic_add v216, v218, s[8:11], s82 offen sc0
s_mov_b64 exec, -1
v_and_b32_dpp v20, v31, v4 row_newbcast:12 row_mask:0xf bank_mask:0xf
v_and_b32_dpp v21, v31, v5 row_newbcast:12 row_mask:0xf bank_mask:0xf
v_and_b32_dpp v22, v31, v6 row_newbcast:12 row_mask:0xf bank_mask:0xf
v_and_b32_dpp v23, v31, v7 row_newbcast:12 row_mask:0xf bank_mask:0xf
v_mfma_f32_16x16x32_bf16 v[12:15], v[16:19], v[136:139], v[12:15]
v_and_b32_dpp v16, v32, v4 row_newbcast:0 row_mask:0xf bank_mask:0xf
v_and_b32_dpp v17, v32, v5 row_newbcast:0 row_mask:0xf bank_mask:0xf
v_and_b32_dpp v18, v32, v6 row_newbcast:0 row_mask:0xf bank_mask:0xf
v_and_b32_dpp v19, v32, v7 row_newbcast:0 row_mask:0xf bank_mask:0xf
v_mfma_f32_16x16x32_bf16 v[12:15], v[20:23], v[140:143], v[12:15]
s_waitcnt vmcnt(4)
buffer_load_dwordx4 v[168:171], v2, s[48:51], s75 offen offset:2048 nt
v_and_b32_dpp v20, v32, v4 row_newbcast:4 row_mask:0xf bank_mask:0xf
v_and_b32_dpp v21, v32, v5 row_newbcast:4 row_mask:0xf bank_mask:0xf
v_and_b32_dpp v22, v32, v6 row_newbcast:4 row_mask:0xf bank_mask:0xf
v_and_b32_dpp v23, v32, v7 row_newbcast:4 row_mask:0xf bank_mask:0xf
v_mfma_f32_16x16x32_bf16 v[12:15], v[16:19], v[144:147], v[12:15]
v_and_b32_dpp v16, v32, v4 row_newbcast:8 row_mask:0xf bank_mask:0xf
v_and_b32_dpp v17, v32, v5 row_newbcast:8 row_mask:0xf bank_mask:0xf
v_and_b32_dpp v18, v32, v6 row_newbcast:8 row_mask:0xf bank_mask:0xf
v_and_b32_dpp v19, v32, v7 row_newbcast:8 row_mask:0xf bank_mask:0xf
v_mfma_f32_16x16x32_bf16 v[12:15], v[20:23], v[148:151], v[12:15]
s_waitcnt vmcnt(4)
buffer_load_dwordx4 v[172:175], v2, s[48:51], s75 offen offset:3072 nt
v_and_b32_dpp v20, v32, v4 row_newbcast:12 row_mask:0xf bank_mask:0xf
v_and_b32_dpp v21, v32, v5 row_newbcast:12 row_mask:0xf bank_mask:0xf
v_and_b32_dpp v22, v32, v6 row_newbcast:12 row_mask:0xf bank_mask:0xf
v_and_b32_dpp v23, v32, v7 row_newbcast:12 row_mask:0xf bank_mask:0xf
v_mfma_f32_16x16x32_bf16 v[12:15], v[16:19], v[152:155], v[12:15]
s_waitcnt vmcnt(4)
s_add_u32 s75, s75, 4096
buffer_load_dwordx4 v[176:179], v2, s[48:51], s75 offen offset:0 nt
v_and_b32_dpp v16, v33, v4 row_newbcast:0 row_mask:0xf bank_mask:0xf
v_and_b32_dpp v17, v33, v5 row_newbcast:0 row_mask:0xf bank_mask:0xf
v_and_b32_dpp v18, v33, v6 row_newbcast:0 row_mask:0xf bank_mask:0xf
v_and_b32_dpp v19, v33, v7 row_newbcast:0 row_mask:0xf bank_mask:0xf
v_mfma_f32_16x16x32_bf16 v[12:15], v[20:23], v[156:159], v[12:15]
s_waitcnt vmcnt(4)
buffer_load_dwordx4 v[180:183], v2, s[48:51], s75 offen offset:1024 nt
v_and_b32_dpp v20, v33, v4 row_newbcast:4 row_mask:0xf bank_mask:0xf
v_and_b32_dpp v21, v33, v5 row_newbcast:4 row_mask:0xf bank_mask:0xf
v_and_b32_dpp v22, v33, v6 row_newbcast:4 row_mask:0xf bank_mask:0xf
v_and_b32_dpp v23, v33, v7 row_newbcast:4 row_mask:0xf bank_mask:0xf
v_mfma_f32_16x16x32_bf16 v[12:15], v[16:19], v[160:163], v[12:15]
L_B_t:
v_lshrrev_b32 v252, 4, v1
s_movk_i32 s68, 5120
v_mul_u32_u24 v252, s68, v252
v_and_b32 v253, 15, v1
v_lshl_add_u32 v252, v253, 4, v252
s_cmp_lt_u32 s5, 5
s_cselect_b32 s68, 0, 0x7f000000
v_or_b32 v252, s68, v252
s_lshl_b32 s68, s4, 3
s_add_u32 s68, s68, s3
s_mul_i32 s74, s68, 20480
s_lshl_b32 s68, s5, 8
s_add_u32 s74, s74, s68
s_mov_b32 s52, s36
s_mov_b32 s53, s37
s_mov_b32 s54, 5242880
s_mov_b32 s55, 0x20000
s_waitcnt vmcnt(4)
v_readfirstlane_b32 s79, v216
s_bitcmp1_b32 s79, 0
s_cbranch_scc1 L_bn_12_r
s_waitcnt vmcnt(0)
v_readfirstlane_b32 s79, v216
L_bn_12_r:
s_lshr_b32 s79, s79, 1
s_cmp_lt_u32 s79, 80
s_cbranch_scc0 L_bn_12
s_mul_i32 s68, s79, 2048
s_add_u32 s68, s68, s83
v_mov_b32 v216, 2
s_mov_b64 exec, 1
buffer_atomic_add v216, v218, s[8:11], s82 offen sc0
s_mov_b64 exec, -1
buffer_load_dwordx4 v[184:187], v2, s[44:47], s68 offen offset:0 nt
buffer_load_dwordx4 v[188:191], v2, s[44:47], s68 offen offset:1024 nt
buffer_load_dwordx4 v[200:203], v2, s[48:51], s68 offen offset:0 nt
buffer_load_dwordx4 v[204:207], v2, s[48:51], s68 offen offset:1024 nt
s_waitcnt vmcnt(8)
v_and_b32_dpp v16, v33, v4 row_newbcast:8 row_mask:0xf bank_mask:0xf
v_and_b32_dpp v17, v33, v5 row_newbcast:8 row_mask:0xf bank_mask:0xf
v_and_b32_dpp v18, v33, v6 row_newbcast:8 row_mask:0xf bank_mask:0xf
v_and_b32_dpp v19, v33, v7 row_newbcast:8 row_mask:0xf bank_mask:0xf
v_mfma_f32_16x16x32_bf16 v[12:15], v[20:23], v[164:167], v[12:15]
s_waitcnt vmcnt(7)
v_and_b32_dpp v20, v33, v4 row_newbcast:12 row_mask:0xf bank_mask:0xf
v_and_b32_dpp v21, v33, v5 row_newbcast:12 row_mask:0xf bank_mask:0xf
v_and_b32_dpp v22, v33, v6 row_newbcast:12 row_mask:0xf bank_mask:0xf
v_and_b32_dpp v23, v33, v7 row_newbcast:12 row_mask:0xf bank_mask:0xf
v_mfma_f32_16x16x32_bf16 v[12:15], v[16:19], v[168:171], v[12:15]
s_waitcnt vmcnt(6)
v_and_b32_dpp v16, v34, v4 row_newbcast:0 row_mask:0xf bank_mask:0xf
v_and_b32_dpp v17, v34, v5 row_newbcast:0 row_mask:0xf bank_mask:0xf
v_and_b32_dpp v18, v34, v6 row_newbcast:0 row_mask:0xf bank_mask:0xf
v_and_b32_dpp v19, v34, v7 row_newbcast:0 row_mask:0xf bank_mask:0xf
v_mfma_f32_16x16x32_bf16 v[12:15], v[20:23], v[172:175], v[12:15]
s_waitcnt vmcnt(5)
v_and_b32_dpp v20, v34, v4 row_newbcast:4 row_mask:0xf bank_mask:0xf
v_and_b32_dpp v21, v34, v5 row_newbcast:4 row_mask:0xf bank_mask:0xf
v_and_b32_dpp v22, v34, v6 row_newbcast:4 row_mask:0xf bank_mask:0xf
v_and_b32_dpp v23, v34, v7 row_newbcast:4 row_mask:0xf bank_mask:0xf
v_mfma_f32_16x16x32_bf16 v[12:15], v[16:19], v[176:179], v[12:15]
s_waitcnt vmcnt(4)
v_mfma_f32_16x16x32_bf16 v[12:15], v[20:23], v[180:183], v[12:15]
L_bu_13:
s_waitcnt vmcnt(2)
v_dot2_f32_bf16 v24, v184, v8, 0
v_dot2_f32_bf16 v25, v188, v8, 0
s_nop 1
v_dot2c_f32_bf16 v24, v185, v9
v_dot2c_f32_bf16 v25, v189, v9
v_dot2c_f32_bf16 v24, v186, v10
v_dot2c_f32_bf16 v25, v190, v10
v_dot2c_f32_bf16 v24, v187, v11
v_dot2c_f32_bf16 v25, v191, v11
v_mov_b32 v28, 0xf149f2ca
v_mov_b32 v29, 0xf149f2ca
s_nop 0
v_add_f32_dpp v28, v24, v24 row_ror:8 row_mask:0xf bank_mask:0x3
v_add_f32_dpp v29, v25, v25 row_ror:8 row_mask:0xf bank_mask:0x3
s_nop 0
v_add_f32_dpp v30, v28, v28 row_half_mirror row_mask:0xf bank_mask:0x5
s_nop 1
v_add_f32_dpp v30, v29, v29 row_half_mirror row_mask:0xf bank_mask:0xa
s_nop 1
v_add_f32_dpp v30, v30, v30 quad_perm:[2,3,0,1] row_mask:0xf bank_mask:0xf
s_nop 1
v_add_f32_dpp v30, v30, v30 quad_perm:[1,0,3,2] row_mask:0xf bank_mask:0xf
v_mov_b32 v250, v30
s_nop 1
v_max_f32_dpp v250, v250, v250 row_ror:4 row_mask:0xf bank_mask:0xf
s_nop 1
v_max_f32_dpp v250, v250, v250 row_ror:8 row_mask:0xf bank_mask:0xf
v_mov_b32 v28, v250
s_nop 1
v_permlane16_swap_b32 v250, v28
v_max_f32 v250, v250, v28
v_mov_b32 v28, v250
s_nop 1
v_permlane32_swap_b32 v250, v28
v_max_f32 v250, v250, v28
v_mul_f32 v250, s80, v250
v_max_f32 v250, v250, v248
v_sub_f32 v251, v248, v250
v_fma_f32 v30, v30, s80, -v250
v_exp_f32 v251, v251
v_exp_f32 v30, v30
v_mov_b32 v248, v250
v_mov_b32 v250, v30
v_cvt_pk_bf16_f32 v30, v30, v30
s_nop 0
v_add_f32_dpp v250, v250, v250 row_ror:4 row_mask:0xf bank_mask:0xf
s_nop 1
v_add_f32_dpp v250, v250, v250 row_ror:8 row_mask:0xf bank_mask:0xf
v_mov_b32 v28, v250
s_nop 1
v_permlane16_swap_b32 v250, v28
v_add_f32 v250, v250, v28
v_mov_b32 v28, v250
s_nop 1
v_permlane32_swap_b32 v250, v28
v_add_f32 v250, v250, v28
v_mul_f32 v12, v251, v12
v_mul_f32 v13, v251, v13
v_mul_f32 v14, v251, v14
v_mul_f32 v15, v251, v15
v_fma_f32 v249, v249, v251, v250
v_and_b32_dpp v16, v30, v4 row_newbcast:0 row_mask:0xf bank_mask:0xf
v_and_b32_dpp v17, v30, v5 row_newbcast:0 row_mask:0xf bank_mask:0xf
v_and_b32_dpp v18, v30, v6 row_newbcast:0 row_mask:0xf bank_mask:0xf
v_and_b32_dpp v19, v30, v7 row_newbcast:0 row_mask:0xf bank_mask:0xf
s_waitcnt vmcnt(0)
v_and_b32_dpp v20, v30, v4 row_newbcast:4 row_mask:0xf bank_mask:0xf
v_and_b32_dpp v21, v30, v5 row_newbcast:4 row_mask:0xf bank_mask:0xf
v_and_b32_dpp v22, v30, v6 row_newbcast:4 row_mask:0xf bank_mask:0xf
v_and_b32_dpp v23, v30, v7 row_newbcast:4 row_mask:0xf bank_mask:0xf
v_mfma_f32_16x16x32_bf16 v[12:15], v[16:19], v[200:203], v[12:15]
s_nop 0
v_mfma_f32_16x16x32_bf16 v[12:15], v[20:23], v[204:207], v[12:15]
v_readfirstlane_b32 s79, v216
s_lshr_b32 s79, s79, 1
s_cmp_lt_u32 s79, 80
s_cbranch_scc0 L_bu_13_x
s_mul_i32 s68, s79, 2048
s_add_u32 s68, s68, s83
v_mov_b32 v216, 2
s_mov_b64 exec, 1
buffer_atomic_add v216, v218, s[8:11], s82 offen sc0
s_mov_b64 exec, -1
buffer_load_dwordx4 v[184:187], v2, s[44:47], s68 offen offset:0 nt
buffer_load_dwordx4 v[188:191], v2, s[44:47], s68 offen offset:1024 nt
buffer_load_dwordx4 v[200:203], v2, s[48:51], s68 offen offset:0 nt
buffer_load_dwordx4 v[204:207], v2, s[48:51], s68 offen offset:1024 nt
s_branch L_bu_13
L_bu_13_x:
buffer_load_dwordx4 v[64:67], v252, s[52:55], s74 offen offset:0 nt
buffer_load_dwordx4 v[68:71], v252, s[52:55], s74 offen offset:1280 nt
buffer_load_dwordx4 v[72:75], v252, s[52:55], s74 offen offset:2560 nt
buffer_load_dwordx4 v[76:79], v252, s[52:55], s74 offen offset:3840 nt
s_branch L_bj_14
L_bn_12:
buffer_load_dwordx4 v[64:67], v252, s[52:55], s74 offen offset:0 nt
buffer_load_dwordx4 v[68:71], v252, s[52:55], s74 offen offset:1280 nt
buffer_load_dwordx4 v[72:75], v252, s[52:55], s74 offen offset:2560 nt
buffer_load_dwordx4 v[76:79], v252, s[52:55], s74 offen offset:3840 nt
s_waitcnt vmcnt(8)
v_and_b32_dpp v16, v33, v4 row_newbcast:8 row_mask:0xf bank_mask:0xf
v_and_b32_dpp v17, v33, v5 row_newbcast:8 row_mask:0xf bank_mask:0xf
v_and_b32_dpp v18, v33, v6 row_newbcast:8 row_mask:0xf bank_mask:0xf
v_and_b32_dpp v19, v33, v7 row_newbcast:8 row_mask:0xf bank_mask:0xf
v_mfma_f32_16x16x32_bf16 v[12:15], v[20:23], v[164:167], v[12:15]
s_waitcnt vmcnt(7)
v_and_b32_dpp v20, v33, v4 row_newbcast:12 row_mask:0xf bank_mask:0xf
v_and_b32_dpp v21, v33, v5 row_newbcast:12 row_mask:0xf bank_mask:0xf
v_and_b32_dpp v22, v33, v6 row_newbcast:12 row_mask:0xf bank_mask:0xf
v_and_b32_dpp v23, v33, v7 row_newbcast:12 row_mask:0xf bank_mask:0xf
v_mfma_f32_16x16x32_bf16 v[12:15], v[16:19], v[168:171], v[12:15]
s_waitcnt vmcnt(6)
v_and_b32_dpp v16, v34, v4 row_newbcast:0 row_mask:0xf bank_mask:0xf
v_and_b32_dpp v17, v34, v5 row_newbcast:0 row_mask:0xf bank_mask:0xf
v_and_b32_dpp v18, v34, v6 row_newbcast:0 row_mask:0xf bank_mask:0xf
v_and_b32_dpp v19, v34, v7 row_newbcast:0 row_mask:0xf bank_mask:0xf
v_mfma_f32_16x16x32_bf16 v[12:15], v[20:23], v[172:175], v[12:15]
s_waitcnt vmcnt(5)
v_and_b32_dpp v20, v34, v4 row_newbcast:4 row_mask:0xf bank_mask:0xf
v_and_b32_dpp v21, v34, v5 row_newbcast:4 row_mask:0xf bank_mask:0xf
v_and_b32_dpp v22, v34, v6 row_newbcast:4 row_mask:0xf bank_mask:0xf
v_and_b32_dpp v23, v34, v7 row_newbcast:4 row_mask:0xf bank_mask:0xf
v_mfma_f32_16x16x32_bf16 v[12:15], v[16:19], v[176:179], v[12:15]
s_waitcnt vmcnt(4)
v_mfma_f32_16x16x32_bf16 v[12:15], v[20:23], v[180:183], v[12:15]
L_bj_14:
s_nop 7
s_lshl_b32 s68, s3, 2
v_mov_b32 v252, s68
s_mov_b32 exec_hi, 0
ds_write_b128 v38, v[12:15] offset:8192
s_mov_b32 exec_lo, 1
ds_write_b32 v252, v248 offset:12288
ds_write_b32 v252, v249 offset:12416
s_mov_b64 exec, -1
v_lshrrev_b32 v58, 4, v1
v_lshlrev_b32 v58, 4, v58
s_mul_i32 s76, s4, 3072
s_add_u32 s78, s76, 208896
s_lshl_b32 s77, s4, 7
s_add_u32 s77, s77, 311296
s_waitcnt lgkmcnt(0)
s_barrier
s_cmp_eq_u32 s3, 0
s_cbranch_scc0 L_b4_15
v_and_b32 v248, 31, v1
v_lshlrev_b32 v248, 4, v248
ds_read_b128 v[144:147], v218 offset:12288
ds_read_b128 v[148:151], v218 offset:12304
ds_read_b128 v[152:155], v218 offset:12416
ds_read_b128 v[156:159], v218 offset:12432
ds_read_b128 v[112:115], v248 offset:8192
ds_read_b128 v[116:119], v248 offset:8704
ds_read_b128 v[120:123], v248 offset:9216
ds_read_b128 v[124:127], v248 offset:9728
ds_read_b128 v[128:131], v248 offset:10240
ds_read_b128 v[132:135], v248 offset:10752
ds_read_b128 v[136:139], v248 offset:11264
ds_read_b128 v[140:143], v248 offset:11776
s_lshl_b32 s68, s5, 9
s_add_u32 s68, s68, s78
s_lshl_b32 s69, s5, 4
s_add_u32 s69, s69, s77
s_waitcnt lgkmcnt(10)
v_max3_f32 v56, v144, v145, v146
v_max3_f32 v56, v56, v147, v148
v_max3_f32 v56, v56, v149, v150
v_max_f32 v56, v56, v151
v_sub_f32 v144, v144, v56
v_sub_f32 v145, v145, v56
v_sub_f32 v146, v146, v56
v_sub_f32 v147, v147, v56
v_sub_f32 v148, v148, v56
v_sub_f32 v149, v149, v56
v_sub_f32 v150, v150, v56
v_sub_f32 v151, v151, v56
v_exp_f32 v144, v144
v_exp_f32 v145, v145
v_exp_f32 v146, v146
v_exp_f32 v147, v147
v_exp_f32 v148, v148
v_exp_f32 v149, v149
v_exp_f32 v150, v150
v_exp_f32 v151, v151
s_waitcnt lgkmcnt(0)
v_mul_f32 v61, v144, v152
v_mul_f32 v112, v144, v112
v_mul_f32 v113, v144, v113
v_mul_f32 v114, v144, v114
v_mul_f32 v115, v144, v115
v_fmac_f32 v61, v145, v153
v_fmac_f32 v112, v145, v116
v_fmac_f32 v113, v145, v117
v_fmac_f32 v114, v145, v118
v_fmac_f32 v115, v145, v119
v_fmac_f32 v61, v146, v154
v_fmac_f32 v112, v146, v120
v_fmac_f32 v113, v146, v121
v_fmac_f32 v114, v146, v122
v_fmac_f32 v115, v146, v123
v_fmac_f32 v61, v147, v155
v_fmac_f32 v112, v147, v124
v_fmac_f32 v113, v147, v125
v_fmac_f32 v114, v147, v126
v_fmac_f32 v115, v147, v127
v_fmac_f32 v61, v148, v156
v_fmac_f32 v112, v148, v128
v_fmac_f32 v113, v148, v129
v_fmac_f32 v114, v148, v130
v_fmac_f32 v115, v148, v131
v_fmac_f32 v61, v149, v157
v_fmac_f32 v112, v149, v132
v_fmac_f32 v113, v149, v133
v_fmac_f32 v114, v149, v134
v_fmac_f32 v115, v149, v135
v_fmac_f32 v61, v150, v158
v_fmac_f32 v112, v150, v136
v_fmac_f32 v113, v150, v137
v_fmac_f32 v114, v150, v138
v_fmac_f32 v115, v150, v139
v_fmac_f32 v61, v151, v159
v_fmac_f32 v112, v151, v140
v_fmac_f32 v113, v151, v141
v_fmac_f32 v114, v151, v142
v_fmac_f32 v115, v151, v143
v_perm_b32 v112, v112, v115, s62
v_perm_b32 v113, v113, v115, s63
v_perm_b32 v114, v114, v115, s64
v_mov_b32 v115, v37
s_mov_b32 exec_hi, 0
buffer_store_dwordx4 v[112:115], v248, s[8:11], s68 offen sc1
v_mov_b32 v60, v56
v_mov_b32 v62, 0
v_mov_b32 v63, v37
s_mov_b32 exec_lo, 1
buffer_store_dwordx4 v[60:63], v218, s[8:11], s69 offen sc1
s_mov_b64 exec, -1
L_b4_15:
s_cmp_lt_u32 s5, 5
s_cbranch_scc0 L_bend_16
s_cmp_eq_u32 s3, 0
s_cbranch_scc0 L_bc_17
v_lshrrev_b32 v249, 5, v1
v_lshlrev_b32 v250, 4, v249
v_lshl_add_u32 v249, v249, 9, v248
s_mov_b32 s81, 0
L_bob_18:
buffer_load_dwordx4 v[160:163], v249, s[8:11], s78 offen offset:0 sc1
buffer_load_dwordx4 v[164:167], v249, s[8:11], s78 offen offset:1024 sc1
buffer_load_dwordx4 v[168:171], v249, s[8:11], s78 offen offset:2048 sc1
buffer_load_dwordx4 v[172:175], v250, s[8:11], s77 offen offset:0 sc1
buffer_load_dwordx4 v[176:179], v250, s[8:11], s77 offen offset:32 sc1
buffer_load_dwordx4 v[180:183], v250, s[8:11], s77 offen offset:64 sc1
s_waitcnt vmcnt(0)
v_cmp_ne_u32 s[6:7], s61, v163
v_cmp_ne_u32 vcc, s61, v167
s_or_b64 s[6:7], s[6:7], vcc
v_cmp_ne_u32 vcc, s61, v171
s_or_b64 s[6:7], s[6:7], vcc
v_cmp_ne_u32 vcc, s61, v175
s_or_b64 s[6:7], s[6:7], vcc
v_cmp_ne_u32 vcc, s61, v179
s_or_b64 s[6:7], s[6:7], vcc
v_cmp_ne_u32 vcc, s61, v183
s_or_b64 s[6:7], s[6:7], vcc
s_cmp_eq_u64 s[6:7], 0
s_cbranch_scc1 L_bob_18_d
s_add_u32 s81, s81, 1
s_cmp_lt_u32 s81, 20000
s_cbranch_scc0 L_bob_18_d
s_branch L_bob_18
L_bob_18_d:
v_max3_f32 v24, v172, v176, v180
v_mov_b32 v26, v24
s_nop 1
v_permlane32_swap_b32 v24, v26
v_max_f32 v24, v24, v26
v_perm_b32 v163, v161, v160, s65
v_lshl_or_b32 v163, v162, 24, v163
v_perm_b32 v167, v165, v164, s65
v_lshl_or_b32 v167, v166, 24, v167
v_perm_b32 v171, v169, v168, s65
v_lshl_or_b32 v171, v170, 24, v171
v_sub_f32 v172, v172, v24
v_sub_f32 v176, v176, v24
v_sub_f32 v180, v180, v24
v_exp_f32 v172, v172
v_exp_f32 v176, v176
v_exp_f32 v180, v180
v_mul_f32 v25, v172, v173
v_mul_f32 v30, v172, v160
v_mul_f32 v31, v172, v161
v_mul_f32 v32, v172, v162
v_mul_f32 v33, v172, v163
v_fmac_f32 v25, v176, v177
v_fmac_f32 v30, v176, v164
v_fmac_f32 v31, v176, v165
v_fmac_f32 v32, v176, v166
v_fmac_f32 v33, v176, v167
v_fmac_f32 v25, v180, v181
v_fmac_f32 v30, v180, v168
v_fmac_f32 v31, v180, v169
v_fmac_f32 v32, v180, v170
v_fmac_f32 v33, v180, v171
v_mov_b32 v160, v25
v_mov_b32 v161, v30
v_mov_b32 v162, v31
v_mov_b32 v163, v32
v_mov_b32 v164, v33
v_permlane32_swap_b32 v25, v160
v_permlane32_swap_b32 v30, v161
v_permlane32_swap_b32 v31, v162
v_permlane32_swap_b32 v32, v163
v_permlane32_swap_b32 v33, v164
v_add_f32 v25, v25, v160
v_add_f32 v30, v30, v161
v_add_f32 v31, v31, v162
v_add_f32 v32, v32, v163
v_add_f32 v33, v33, v164
v_rcp_f32 v25, v25
s_nop 0
v_mul_f32 v30, v25, v30
v_mul_f32 v31, v25, v31
v_mul_f32 v32, v25, v32
v_mul_f32 v33, v25, v33
v_cvt_pk_bf16_f32 v30, v30, v30
v_cvt_pk_bf16_f32 v31, v31, v31
v_cvt_pk_bf16_f32 v32, v32, v32
v_cvt_pk_bf16_f32 v33, v33, v33
s_mov_b32 exec_hi, 0
ds_write_b128 v248, v[30:33] offset:24576
s_mov_b64 exec, -1
s_waitcnt lgkmcnt(0)
s_branch L_bc_17_j
L_bc_17:
s_waitcnt vmcnt(0)
L_bc_17_j:
s_lshl_b32 s68, s3, 6
v_add_u32 v58, s68, v58
s_barrier
ds_read_b128 v[30:33], v58 offset:24576
s_waitcnt lgkmcnt(0)
v_and_b32 v16, v30, v4
v_and_b32 v17, v30, v5
v_and_b32 v18, v30, v6
v_and_b32 v19, v30, v7
v_and_b32 v20, v31, v4
v_and_b32 v21, v31, v5
v_and_b32 v22, v31, v6
v_and_b32 v23, v31, v7
v_mfma_f32_16x16x32_bf16 v[12:15], v[16:19], v[64:67], 0
v_and_b32 v16, v32, v4
v_and_b32 v17, v32, v5
v_and_b32 v18, v32, v6
v_and_b32 v19, v32, v7
v_mfma_f32_16x16x32_bf16 v[12:15], v[20:23], v[68:71], v[12:15]
v_and_b32 v20, v33, v4
v_and_b32 v21, v33, v5
v_and_b32 v22, v33, v6
v_and_b32 v23, v33, v7
v_mfma_f32_16x16x32_bf16 v[12:15], v[16:19], v[72:75], v[12:15]
s_nop 0
v_mfma_f32_16x16x32_bf16 v[12:15], v[20:23], v[76:79], v[12:15]
s_mov_b32 exec_hi, 0
s_nop 6
ds_write_b128 v38, v[12:15] offset:20480
s_mov_b64 exec, -1
s_waitcnt lgkmcnt(0)
s_barrier
s_cmp_eq_u32 s3, 0
s_cbranch_scc0 L_bend_16
v_and_b32 v248, 31, v1
v_lshlrev_b32 v248, 4, v248
ds_read_b128 v[112:115], v248 offset:20480
ds_read_b128 v[116:119], v248 offset:20992
ds_read_b128 v[120:123], v248 offset:21504
ds_read_b128 v[124:127], v248 offset:22016
ds_read_b128 v[128:131], v248 offset:22528
ds_read_b128 v[132:135], v248 offset:23040
ds_read_b128 v[136:139], v248 offset:23552
ds_read_b128 v[140:143], v248 offset:24064
s_mul_i32 s68, s4, 2560
s_lshl_b32 s69, s5, 9
s_add_u32 s68, s68, s69
s_add_u32 s68, s68, 557056
s_waitcnt lgkmcnt(0)
v_pk_add_f32 v[112:113], v[112:113], v[116:117]
v_pk_add_f32 v[114:115], v[114:115], v[118:119]
v_pk_add_f32 v[120:121], v[120:121], v[124:125]
v_pk_add_f32 v[122:123], v[122:123], v[126:127]
v_pk_add_f32 v[128:129], v[128:129], v[132:133]
v_pk_add_f32 v[130:131], v[130:131], v[134:135]
v_pk_add_f32 v[136:137], v[136:137], v[140:141]
v_pk_add_f32 v[138:139], v[138:139], v[142:143]
v_pk_add_f32 v[112:113], v[112:113], v[120:121]
v_pk_add_f32 v[114:115], v[114:115], v[122:123]
v_pk_add_f32 v[128:129], v[128:129], v[136:137]
v_pk_add_f32 v[130:131], v[130:131], v[138:139]
v_pk_add_f32 v[112:113], v[112:113], v[128:129]
v_pk_add_f32 v[114:115], v[114:115], v[130:131]
v_perm_b32 v112, v112, v115, s62
v_perm_b32 v113, v113, v115, s63
v_perm_b32 v114, v114, v115, s64
v_mov_b32 v115, v37
s_mov_b32 exec_hi, 0
buffer_store_dwordx4 v[112:115], v248, s[8:11], s68 offen sc1
s_mov_b64 exec, -1
L_bend_16:
s_endpgm
L_PR:
s_cmp_eq_u32 s3, 7
s_cbranch_scc0 L_pf_19
s_getpc_b64 s[70:71]
L_pf_19_pc:
s_sub_u32 s70, s70, L_pf_19_pc-L_PR
s_subb_u32 s71, s71, 0
v_lshlrev_b32 v254, 7, v1
v_min_u32 v254, L_Q-L_PR-4, v254
global_load_dword v255, v254, s[70:71]
L_pf_19:
s_add_u32 s4, s6, s7
v_lshrrev_b32 v42, 4, v1
v_and_b32 v43, 15, v1
v_lshlrev_b32 v43, 4, v43
v_lshl_add_u32 v2, v42, 16, v43
v_lshl_add_u32 v3, v42, 17, v43
s_and_b32 s68, s3, 3
s_add_u32 s79, s68, s6
s_lshr_b32 s70, s3, 2
s_lshl_b32 s71, s7, 1
s_add_u32 s70, s70, s71
s_lshl_b32 s73, s70, 19
s_lshl_b32 s69, s79, 8
s_add_u32 s73, s73, s69
s_lshl_b32 s74, s3, 19
s_lshl_b32 s69, s4, 8
s_add_u32 s74, s74, s69
s_mul_i32 s76, s79, 3072
s_add_u32 s76, s76, 106496
s_waitcnt lgkmcnt(0)
s_mov_b32 s48, s22
s_mov_b32 s49, s23
s_mov_b32 s50, 4194304
s_mov_b32 s51, 0x20000
buffer_load_dwordx4 v[64:67], v2, s[48:51], s73 offen nt
s_add_u32 s73, s73, 8192
buffer_load_dwordx4 v[68:71], v2, s[48:51], s73 offen nt
s_add_u32 s73, s73, 8192
buffer_load_dwordx4 v[72:75], v2, s[48:51], s73 offen nt
s_add_u32 s73, s73, 8192
buffer_load_dwordx4 v[76:79], v2, s[48:51], s73 offen nt
s_add_u32 s73, s73, 8192
buffer_load_dwordx4 v[80:83], v2, s[48:51], s73 offen nt
s_add_u32 s73, s73, 8192
buffer_load_dwordx4 v[84:87], v2, s[48:51], s73 offen nt
s_add_u32 s73, s73, 8192
buffer_load_dwordx4 v[88:91], v2, s[48:51], s73 offen nt
s_add_u32 s73, s73, 8192
buffer_load_dwordx4 v[92:95], v2, s[48:51], s73 offen nt
s_add_u32 s73, s73, 204800
buffer_load_dwordx4 v[96:99], v2, s[48:51], s73 offen nt
s_add_u32 s73, s73, 8192
buffer_load_dwordx4 v[100:103], v2, s[48:51], s73 offen nt
s_add_u32 s73, s73, 8192
buffer_load_dwordx4 v[104:107], v2, s[48:51], s73 offen nt
s_add_u32 s73, s73, 8192
buffer_load_dwordx4 v[108:111], v2, s[48:51], s73 offen nt
s_add_u32 s73, s73, 8192
buffer_load_dwordx4 v[112:115], v2, s[48:51], s73 offen nt
s_add_u32 s73, s73, 8192
buffer_load_dwordx4 v[116:119], v2, s[48:51], s73 offen nt
s_add_u32 s73, s73, 8192
buffer_load_dwordx4 v[120:123], v2, s[48:51], s73 offen nt
s_add_u32 s73, s73, 8192
buffer_load_dwordx4 v[124:127], v2, s[48:51], s73 offen nt
s_load_dword s60, s[42:43], 0
s_mov_b32 s8, s42
s_mov_b32 s9, s43
s_mov_b32 s10, 3145728
s_mov_b32 s11, 0x20000
s_mov_b32 s12, s38
s_mov_b32 s13, s39
s_mov_b32 s14, 2560
s_mov_b32 s15, 0x20000
s_mov_b32 s52, s24
s_mov_b32 s53, s25
s_mov_b32 s54, 4194304
s_mov_b32 s55, 0x20000
v_and_b32 v40, 1, v1
v_lshlrev_b32 v40, 4, v40
v_mov_b32 v41, 0xffff
v_lshlrev_b32 v40, v40, v41
v_bfe_u32 v41, v1, 1, 2
v_cmp_eq_u32 vcc, 0, v41
s_nop 1
v_cndmask_b32 v4, 0, v40, vcc
v_cmp_eq_u32 vcc, 1, v41
s_nop 1
v_cndmask_b32 v5, 0, v40, vcc
v_cmp_eq_u32 vcc, 2, v41
s_nop 1
v_cndmask_b32 v6, 0, v40, vcc
v_cmp_eq_u32 vcc, 3, v41
s_nop 1
v_cndmask_b32 v7, 0, v40, vcc
v_and_b32 v40, 15, v1
v_bfe_u32 v41, v1, 4, 1
v_lshl_add_u32 v40, v40, 1, v41
v_lshlrev_b32 v40, 4, v40
s_lshl_b32 s68, s3, 9
v_add_u32 v37, s68, v40
s_waitcnt lgkmcnt(0)
s_mul_i32 s61, s60, 0x9E3779B1
s_add_u32 s61, s61, 0x85EBCA6B
v_mov_b32 v36, s61
v_and_b32 v40, 31, v1
v_lshlrev_b32 v40, 4, v40
s_waitcnt vmcnt(3)
s_mov_b32 s81, 0
L_pq_20:
buffer_load_dwordx4 v[192:195], v40, s[8:11], s76 offen offset:0 sc1
buffer_load_dwordx4 v[196:199], v40, s[8:11], s76 offen offset:512 sc1
buffer_load_dwordx4 v[200:203], v40, s[8:11], s76 offen offset:1024 sc1
buffer_load_dwordx4 v[204:207], v40, s[8:11], s76 offen offset:1536 sc1
buffer_load_dwordx4 v[208:211], v40, s[8:11], s76 offen offset:2048 sc1
buffer_load_dwordx4 v[212:215], v40, s[8:11], s76 offen offset:2560 sc1
s_waitcnt vmcnt(0)
v_cmp_ne_u32 s[6:7], s61, v195
v_cmp_ne_u32 vcc, s61, v199
s_or_b64 s[6:7], s[6:7], vcc
v_cmp_ne_u32 vcc, s61, v203
s_or_b64 s[6:7], s[6:7], vcc
v_cmp_ne_u32 vcc, s61, v207
s_or_b64 s[6:7], s[6:7], vcc
v_cmp_ne_u32 vcc, s61, v211
s_or_b64 s[6:7], s[6:7], vcc
v_cmp_ne_u32 vcc, s61, v215
s_or_b64 s[6:7], s[6:7], vcc
s_cmp_eq_u64 s[6:7], 0
s_cbranch_scc1 L_pq_20_d
s_add_u32 s81, s81, 1
s_cmp_lt_u32 s81, 20000
s_cbranch_scc0 L_pq_20_d
s_sleep 1
s_branch L_pq_20
L_pq_20_d:
v_perm_b32 v195, v193, v192, s65
v_lshl_or_b32 v195, v194, 24, v195
v_perm_b32 v199, v197, v196, s65
v_lshl_or_b32 v199, v198, 24, v199
v_perm_b32 v203, v201, v200, s65
v_lshl_or_b32 v203, v202, 24, v203
v_perm_b32 v207, v205, v204, s65
v_lshl_or_b32 v207, v206, 24, v207
v_perm_b32 v211, v209, v208, s65
v_lshl_or_b32 v211, v210, 24, v211
v_perm_b32 v215, v213, v212, s65
v_lshl_or_b32 v215, v214, 24, v215
v_pk_add_f32 v[192:193], v[192:193], v[196:197]
v_pk_add_f32 v[194:195], v[194:195], v[198:199]
v_pk_add_f32 v[200:201], v[200:201], v[204:205]
v_pk_add_f32 v[202:203], v[202:203], v[206:207]
v_pk_add_f32 v[208:209], v[208:209], v[212:213]
v_pk_add_f32 v[210:211], v[210:211], v[214:215]
v_pk_add_f32 v[192:193], v[192:193], v[200:201]
v_pk_add_f32 v[194:195], v[194:195], v[202:203]
v_pk_add_f32 v[192:193], v[192:193], v[208:209]
v_pk_add_f32 v[194:195], v[194:195], v[210:211]
v_cvt_pk_bf16_f32 v192, v192, v193
v_cvt_pk_bf16_f32 v193, v194, v195
s_lshl_b32 s68, s3, 8
v_lshrrev_b32 v40, 1, v40
v_add_u32 v40, s68, v40
s_mov_b32 exec_hi, 0
ds_write_b64 v40, v[192:193] offset:8192
s_mov_b64 exec, -1
v_and_b32 v40, 15, v1
v_lshlrev_b32 v40, 4, v40
v_add_u32 v40, s68, v40
s_waitcnt lgkmcnt(0)
ds_read_b128 v[8:11], v40 offset:8192
v_lshrrev_b32 v40, 3, v1
v_lshlrev_b32 v40, 4, v40
s_lshl_b32 s68, s79, 11
s_lshl_b32 s69, s70, 8
s_add_u32 s68, s68, s69
s_add_u32 s68, s68, 393216
s_waitcnt lgkmcnt(0)
v_dot2_f32_bf16 v24, v64, v8, 0
v_dot2_f32_bf16 v25, v68, v8, 0
v_dot2_f32_bf16 v26, v72, v8, 0
v_dot2_f32_bf16 v27, v76, v8, 0
v_dot2_f32_bf16 v28, v80, v8, 0
v_dot2_f32_bf16 v29, v84, v8, 0
v_dot2_f32_bf16 v30, v88, v8, 0
v_dot2_f32_bf16 v31, v92, v8, 0
v_dot2c_f32_bf16 v24, v65, v9
v_dot2c_f32_bf16 v25, v69, v9
v_dot2c_f32_bf16 v26, v73, v9
v_dot2c_f32_bf16 v27, v77, v9
v_dot2c_f32_bf16 v28, v81, v9
v_dot2c_f32_bf16 v29, v85, v9
v_dot2c_f32_bf16 v30, v89, v9
v_dot2c_f32_bf16 v31, v93, v9
v_dot2c_f32_bf16 v24, v66, v10
v_dot2c_f32_bf16 v25, v70, v10
v_dot2c_f32_bf16 v26, v74, v10
v_dot2c_f32_bf16 v27, v78, v10
v_dot2c_f32_bf16 v28, v82, v10
v_dot2c_f32_bf16 v29, v86, v10
v_dot2c_f32_bf16 v30, v90, v10
v_dot2c_f32_bf16 v31, v94, v10
v_dot2c_f32_bf16 v24, v67, v11
v_dot2c_f32_bf16 v25, v71, v11
v_dot2c_f32_bf16 v26, v75, v11
v_dot2c_f32_bf16 v27, v79, v11
v_dot2c_f32_bf16 v28, v83, v11
v_dot2c_f32_bf16 v29, v87, v11
v_dot2c_f32_bf16 v30, v91, v11
v_dot2c_f32_bf16 v31, v95, v11
v_add_f32_dpp v32, v24, v24 row_ror:8 row_mask:0xf bank_mask:0x3
v_add_f32_dpp v33, v25, v25 row_ror:8 row_mask:0xf bank_mask:0x3
v_add_f32_dpp v34, v26, v26 row_ror:8 row_mask:0xf bank_mask:0x3
v_add_f32_dpp v35, v27, v27 row_ror:8 row_mask:0xf bank_mask:0x3
v_add_f32_dpp v32, v28, v28 row_ror:8 row_mask:0xf bank_mask:0xc
v_add_f32_dpp v33, v29, v29 row_ror:8 row_mask:0xf bank_mask:0xc
v_add_f32_dpp v34, v30, v30 row_ror:8 row_mask:0xf bank_mask:0xc
v_add_f32_dpp v35, v31, v31 row_ror:8 row_mask:0xf bank_mask:0xc
v_add_f32_dpp v32, v32, v32 row_half_mirror row_mask:0xf bank_mask:0xf
v_add_f32_dpp v33, v33, v33 row_half_mirror row_mask:0xf bank_mask:0xf
v_add_f32_dpp v34, v34, v34 row_half_mirror row_mask:0xf bank_mask:0xf
v_add_f32_dpp v35, v35, v35 row_half_mirror row_mask:0xf bank_mask:0xf
v_add_f32_dpp v32, v32, v32 quad_perm:[2,3,0,1] row_mask:0xf bank_mask:0xf
v_add_f32_dpp v33, v33, v33 quad_perm:[2,3,0,1] row_mask:0xf bank_mask:0xf
v_add_f32_dpp v34, v34, v34 quad_perm:[2,3,0,1] row_mask:0xf bank_mask:0xf
v_add_f32_dpp v35, v35, v35 quad_perm:[2,3,0,1] row_mask:0xf bank_mask:0xf
v_add_f32_dpp v32, v32, v32 quad_perm:[1,0,3,2] row_mask:0xf bank_mask:0xf
v_add_f32_dpp v33, v33, v33 quad_perm:[1,0,3,2] row_mask:0xf bank_mask:0xf
v_add_f32_dpp v34, v34, v34 quad_perm:[1,0,3,2] row_mask:0xf bank_mask:0xf
v_add_f32_dpp v35, v35, v35 quad_perm:[1,0,3,2] row_mask:0xf bank_mask:0xf
v_perm_b32 v32, v32, v35, s62
v_perm_b32 v33, v33, v35, s63
v_perm_b32 v34, v34, v35, s64
v_mov_b32 v35, v36
s_mov_b32 exec_lo, 0x01010101
s_mov_b32 exec_hi, 0x01010101
buffer_store_dwordx4 v[32:35], v40, s[8:11], s68 offen offset:0 sc1
s_mov_b64 exec, -1
v_dot2_f32_bf16 v24, v96, v8, 0
v_dot2_f32_bf16 v25, v100, v8, 0
v_dot2_f32_bf16 v26, v104, v8, 0
v_dot2_f32_bf16 v27, v108, v8, 0
v_dot2_f32_bf16 v28, v112, v8, 0
v_dot2_f32_bf16 v29, v116, v8, 0
v_dot2_f32_bf16 v30, v120, v8, 0
v_dot2_f32_bf16 v31, v124, v8, 0
v_dot2c_f32_bf16 v24, v97, v9
v_dot2c_f32_bf16 v25, v101, v9
v_dot2c_f32_bf16 v26, v105, v9
v_dot2c_f32_bf16 v27, v109, v9
v_dot2c_f32_bf16 v28, v113, v9
v_dot2c_f32_bf16 v29, v117, v9
v_dot2c_f32_bf16 v30, v121, v9
v_dot2c_f32_bf16 v31, v125, v9
v_dot2c_f32_bf16 v24, v98, v10
v_dot2c_f32_bf16 v25, v102, v10
v_dot2c_f32_bf16 v26, v106, v10
v_dot2c_f32_bf16 v27, v110, v10
v_dot2c_f32_bf16 v28, v114, v10
v_dot2c_f32_bf16 v29, v118, v10
v_dot2c_f32_bf16 v30, v122, v10
v_dot2c_f32_bf16 v31, v126, v10
v_dot2c_f32_bf16 v24, v99, v11
v_dot2c_f32_bf16 v25, v103, v11
v_dot2c_f32_bf16 v26, v107, v11
v_dot2c_f32_bf16 v27, v111, v11
v_dot2c_f32_bf16 v28, v115, v11
v_dot2c_f32_bf16 v29, v119, v11
v_dot2c_f32_bf16 v30, v123, v11
v_dot2c_f32_bf16 v31, v127, v11
v_add_f32_dpp v48, v24, v24 row_ror:8 row_mask:0xf bank_mask:0x3
v_add_f32_dpp v49, v25, v25 row_ror:8 row_mask:0xf bank_mask:0x3
v_add_f32_dpp v50, v26, v26 row_ror:8 row_mask:0xf bank_mask:0x3
v_add_f32_dpp v51, v27, v27 row_ror:8 row_mask:0xf bank_mask:0x3
v_add_f32_dpp v48, v28, v28 row_ror:8 row_mask:0xf bank_mask:0xc
v_add_f32_dpp v49, v29, v29 row_ror:8 row_mask:0xf bank_mask:0xc
v_add_f32_dpp v50, v30, v30 row_ror:8 row_mask:0xf bank_mask:0xc
v_add_f32_dpp v51, v31, v31 row_ror:8 row_mask:0xf bank_mask:0xc
v_add_f32_dpp v48, v48, v48 row_half_mirror row_mask:0xf bank_mask:0xf
v_add_f32_dpp v49, v49, v49 row_half_mirror row_mask:0xf bank_mask:0xf
v_add_f32_dpp v50, v50, v50 row_half_mirror row_mask:0xf bank_mask:0xf
v_add_f32_dpp v51, v51, v51 row_half_mirror row_mask:0xf bank_mask:0xf
v_add_f32_dpp v48, v48, v48 quad_perm:[2,3,0,1] row_mask:0xf bank_mask:0xf
v_add_f32_dpp v49, v49, v49 quad_perm:[2,3,0,1] row_mask:0xf bank_mask:0xf
v_add_f32_dpp v50, v50, v50 quad_perm:[2,3,0,1] row_mask:0xf bank_mask:0xf
v_add_f32_dpp v51, v51, v51 quad_perm:[2,3,0,1] row_mask:0xf bank_mask:0xf
v_add_f32_dpp v48, v48, v48 quad_perm:[1,0,3,2] row_mask:0xf bank_mask:0xf
v_add_f32_dpp v49, v49, v49 quad_perm:[1,0,3,2] row_mask:0xf bank_mask:0xf
v_add_f32_dpp v50, v50, v50 quad_perm:[1,0,3,2] row_mask:0xf bank_mask:0xf
v_add_f32_dpp v51, v51, v51 quad_perm:[1,0,3,2] row_mask:0xf bank_mask:0xf
v_perm_b32 v48, v48, v51, s62
v_perm_b32 v49, v49, v51, s63
v_perm_b32 v50, v50, v51, s64
v_mov_b32 v51, v36
s_mov_b32 exec_lo, 0x01010101
s_mov_b32 exec_hi, 0x01010101
buffer_store_dwordx4 v[48:51], v40, s[8:11], s68 offen offset:128 sc1
s_mov_b64 exec, -1
s_barrier
buffer_load_dwordx4 v[128:131], v3, s[52:55], s74 offen nt
s_add_u32 s74, s74, 8192
buffer_load_dwordx4 v[132:135], v3, s[52:55], s74 offen nt
s_add_u32 s74, s74, 8192
buffer_load_dwordx4 v[136:139], v3, s[52:55], s74 offen nt
s_add_u32 s74, s74, 8192
buffer_load_dwordx4 v[140:143], v3, s[52:55], s74 offen nt
s_add_u32 s74, s74, 8192
buffer_load_dwordx4 v[144:147], v3, s[52:55], s74 offen nt
s_add_u32 s74, s74, 8192
buffer_load_dwordx4 v[148:151], v3, s[52:55], s74 offen nt
s_add_u32 s74, s74, 8192
buffer_load_dwordx4 v[152:155], v3, s[52:55], s74 offen nt
s_add_u32 s74, s74, 8192
buffer_load_dwordx4 v[156:159], v3, s[52:55], s74 offen nt
s_add_u32 s74, s74, 8192
buffer_load_dwordx4 v[160:163], v3, s[52:55], s74 offen nt
s_add_u32 s74, s74, 8192
buffer_load_dwordx4 v[164:167], v3, s[52:55], s74 offen nt
s_add_u32 s74, s74, 8192
buffer_load_dwordx4 v[168:171], v3, s[52:55], s74 offen nt
s_add_u32 s74, s74, 8192
buffer_load_dwordx4 v[172:175], v3, s[52:55], s74 offen nt
s_add_u32 s74, s74, 8192
buffer_load_dwordx4 v[176:179], v3, s[52:55], s74 offen nt
s_add_u32 s74, s74, 8192
buffer_load_dwordx4 v[180:183], v3, s[52:55], s74 offen nt
s_add_u32 s74, s74, 8192
buffer_load_dwordx4 v[184:187], v3, s[52:55], s74 offen nt
s_add_u32 s74, s74, 8192
buffer_load_dwordx4 v[188:191], v3, s[52:55], s74 offen nt
s_cmp_eq_u32 s3, 7
s_cbranch_scc0 L_pf_21
s_getpc_b64 s[70:71]
L_pf_21_pc:
s_add_u32 s70, s70, L_PR_t-L_pf_21_pc
s_addc_u32 s71, s71, 0
v_lshlrev_b32 v254, 7, v1
v_min_u32 v254, L_Q-L_PR_t-4, v254
global_load_dword v255, v254, s[70:71]
L_pf_21:
L_PR_t:
v_lshrrev_b32 v40, 3, v1
v_lshlrev_b32 v42, 4, v40
v_and_b32 v41, 7, v1
v_lshlrev_b32 v41, 4, v41
v_lshl_add_u32 v43, v40, 10, v41
s_lshl_b32 s76, s4, 9
s_add_u32 s76, s76, 327680
s_lshl_b32 s78, s4, 15
s_lshl_b32 s68, s3, 7
s_add_u32 s78, s78, s68
s_add_u32 s78, s78, 1048576
s_mov_b32 s81, 0
L_pml_22:
buffer_load_dwordx4 v[208:211], v42, s[8:11], s76 offen offset:0 sc1
buffer_load_dwordx4 v[212:215], v42, s[8:11], s76 offen offset:128 sc1
buffer_load_dwordx4 v[216:219], v42, s[8:11], s76 offen offset:256 sc1
buffer_load_dwordx4 v[220:223], v42, s[8:11], s76 offen offset:384 sc1
s_waitcnt vmcnt(0)
v_cmp_ne_u32 s[6:7], s61, v211
v_cmp_ne_u32 vcc, s61, v215
s_or_b64 s[6:7], s[6:7], vcc
v_cmp_ne_u32 vcc, s61, v219
s_or_b64 s[6:7], s[6:7], vcc
v_cmp_ne_u32 vcc, s61, v223
s_or_b64 s[6:7], s[6:7], vcc
s_cmp_eq_u64 s[6:7], 0
s_cbranch_scc1 L_pml_22_d
s_add_u32 s81, s81, 1
s_cmp_lt_u32 s81, 20000
s_cbranch_scc0 L_pml_22_d
s_sleep 2
s_branch L_pml_22
L_pml_22_d:
buffer_load_dwordx4 v[192:195], v43, s[8:11], s78 offen sc1
s_add_u32 s78, s78, 8192
buffer_load_dwordx4 v[196:199], v43, s[8:11], s78 offen sc1
s_add_u32 s78, s78, 8192
buffer_load_dwordx4 v[200:203], v43, s[8:11], s78 offen sc1
s_add_u32 s78, s78, 8192
buffer_load_dwordx4 v[204:207], v43, s[8:11], s78 offen sc1
v_max3_f32 v24, v208, v212, v216
v_max_f32 v24, v24, v220
s_nop 1
v_max_f32_dpp v24, v24, v24 row_ror:8 row_mask:0xf bank_mask:0xf
v_mov_b32 v26, v24
s_nop 1
v_permlane16_swap_b32 v24, v26
v_max_f32 v24, v24, v26
v_mov_b32 v26, v24
s_nop 1
v_permlane32_swap_b32 v24, v26
v_max_f32 v24, v24, v26
v_sub_f32 v208, v208, v24
v_sub_f32 v212, v212, v24
v_sub_f32 v216, v216, v24
v_sub_f32 v220, v220, v24
v_exp_f32 v208, v208
v_exp_f32 v212, v212
v_exp_f32 v216, v216
v_exp_f32 v220, v220
v_mul_f32 v25, v208, v209
v_fmac_f32 v25, v212, v213
v_fmac_f32 v25, v216, v217
v_fmac_f32 v25, v220, v221
s_nop 1
v_add_f32_dpp v25, v25, v25 row_ror:8 row_mask:0xf bank_mask:0xf
v_mov_b32 v26, v25
s_nop 1
v_permlane16_swap_b32 v25, v26
v_add_f32 v25, v25, v26
v_mov_b32 v26, v25
s_nop 1
v_permlane32_swap_b32 v25, v26
v_add_f32 v25, v25, v26
v_rcp_f32 v25, v25
s_nop 0
v_mul_f32 v208, v25, v208
v_mul_f32 v212, v25, v212
v_mul_f32 v216, v25, v216
v_mul_f32 v220, v25, v220
v_cvt_pk_bf16_f32 v208, v208, v208
v_cvt_pk_bf16_f32 v212, v212, v212
v_cvt_pk_bf16_f32 v216, v216, v216
v_cvt_pk_bf16_f32 v220, v220, v220
v_and_b32 v40, 7, v1
v_bfe_u32 v41, v1, 4, 1
v_lshl_add_u32 v40, v40, 1, v41
v_lshlrev_b32 v40, 4, v40
s_lshl_b32 s68, s3, 8
v_add_u32 v40, s68, v40
v_lshrrev_b32 v41, 4, v1
v_lshlrev_b32 v41, 6, v41
v_add_u32 v41, s68, v41
s_waitcnt vmcnt(0)
v_and_b32 v16, v208, v4
v_and_b32 v17, v208, v5
v_and_b32 v18, v208, v6
v_and_b32 v19, v208, v7
v_and_b32 v20, v212, v4
v_and_b32 v21, v212, v5
v_and_b32 v22, v212, v6
v_and_b32 v23, v212, v7
v_mfma_f32_16x16x32_bf16 v[12:15], v[16:19], v[192:195], 0
v_and_b32 v16, v216, v4
v_and_b32 v17, v216, v5
v_and_b32 v18, v216, v6
v_and_b32 v19, v216, v7
v_mfma_f32_16x16x32_bf16 v[12:15], v[20:23], v[196:199], v[12:15]
v_and_b32 v20, v220, v4
v_and_b32 v21, v220, v5
v_and_b32 v22, v220, v6
v_and_b32 v23, v220, v7
v_mfma_f32_16x16x32_bf16 v[12:15], v[16:19], v[200:203], v[12:15]
s_nop 0
v_mfma_f32_16x16x32_bf16 v[12:15], v[20:23], v[204:207], v[12:15]
s_nop 7
v_mov_b32 v24, v12
v_mov_b32 v25, v13
v_mov_b32 v26, v14
v_mov_b32 v27, v15
v_permlane32_swap_b32 v12, v24
v_permlane32_swap_b32 v13, v25
v_permlane32_swap_b32 v14, v26
v_permlane32_swap_b32 v15, v27
v_add_f32_dpp v12, v24, v12 row_shl:8 row_mask:0xf bank_mask:0x3
v_add_f32_dpp v13, v25, v13 row_shl:8 row_mask:0xf bank_mask:0x3
v_add_f32_dpp v14, v26, v14 row_shl:8 row_mask:0xf bank_mask:0x3
v_add_f32_dpp v15, v27, v15 row_shl:8 row_mask:0xf bank_mask:0x3
v_cvt_pk_bf16_f32 v12, v12, v12
v_cvt_pk_bf16_f32 v13, v13, v13
v_cvt_pk_bf16_f32 v14, v14, v14
v_cvt_pk_bf16_f32 v15, v15, v15
s_mov_b32 exec_lo, 0x00ff00ff
s_mov_b32 exec_hi, 0
ds_write_b128 v40, v[12:15] offset:8192
s_mov_b64 exec, -1
s_waitcnt lgkmcnt(0)
ds_read_b128 v[48:51], v41 offset:8192
ds_read_b128 v[52:55], v41 offset:8208
ds_read_b128 v[56:59], v41 offset:8224
ds_read_b128 v[60:63], v41 offset:8240
s_waitcnt lgkmcnt(0)
v_and_b32 v16, v48, v4
v_and_b32 v17, v48, v5
v_and_b32 v18, v48, v6
v_and_b32 v19, v48, v7
v_and_b32 v20, v49, v4
v_and_b32 v21, v49, v5
v_and_b32 v22, v49, v6
v_and_b32 v23, v49, v7
v_mfma_f32_16x16x32_bf16 v[12:15], v[16:19], v[128:131], 0
v_and_b32 v16, v50, v4
v_and_b32 v17, v50, v5
v_and_b32 v18, v50, v6
v_and_b32 v19, v50, v7
v_mfma_f32_16x16x32_bf16 v[12:15], v[20:23], v[132:135], v[12:15]
v_and_b32 v20, v51, v4
v_and_b32 v21, v51, v5
v_and_b32 v22, v51, v6
v_and_b32 v23, v51, v7
v_mfma_f32_16x16x32_bf16 v[12:15], v[16:19], v[136:139], v[12:15]
v_and_b32 v16, v52, v4
v_and_b32 v17, v52, v5
v_and_b32 v18, v52, v6
v_and_b32 v19, v52, v7
v_mfma_f32_16x16x32_bf16 v[12:15], v[20:23], v[140:143], v[12:15]
v_and_b32 v20, v53, v4
v_and_b32 v21, v53, v5
v_and_b32 v22, v53, v6
v_and_b32 v23, v53, v7
v_mfma_f32_16x16x32_bf16 v[12:15], v[16:19], v[144:147], v[12:15]
v_and_b32 v16, v54, v4
v_and_b32 v17, v54, v5
v_and_b32 v18, v54, v6
v_and_b32 v19, v54, v7
v_mfma_f32_16x16x32_bf16 v[12:15], v[20:23], v[148:151], v[12:15]
v_and_b32 v20, v55, v4
v_and_b32 v21, v55, v5
v_and_b32 v22, v55, v6
v_and_b32 v23, v55, v7
v_mfma_f32_16x16x32_bf16 v[12:15], v[16:19], v[152:155], v[12:15]
v_and_b32 v16, v56, v4
v_and_b32 v17, v56, v5
v_and_b32 v18, v56, v6
v_and_b32 v19, v56, v7
v_mfma_f32_16x16x32_bf16 v[12:15], v[20:23], v[156:159], v[12:15]
v_and_b32 v20, v57, v4
v_and_b32 v21, v57, v5
v_and_b32 v22, v57, v6
v_and_b32 v23, v57, v7
v_mfma_f32_16x16x32_bf16 v[12:15], v[16:19], v[160:163], v[12:15]
v_and_b32 v16, v58, v4
v_and_b32 v17, v58, v5
v_and_b32 v18, v58, v6
v_and_b32 v19, v58, v7
v_mfma_f32_16x16x32_bf16 v[12:15], v[20:23], v[164:167], v[12:15]
v_and_b32 v20, v59, v4
v_and_b32 v21, v59, v5
v_and_b32 v22, v59, v6
v_and_b32 v23, v59, v7
v_mfma_f32_16x16x32_bf16 v[12:15], v[16:19], v[168:171], v[12:15]
v_and_b32 v16, v60, v4
v_and_b32 v17, v60, v5
v_and_b32 v18, v60, v6
v_and_b32 v19, v60, v7
v_mfma_f32_16x16x32_bf16 v[12:15], v[20:23], v[172:175], v[12:15]
v_and_b32 v20, v61, v4
v_and_b32 v21, v61, v5
v_and_b32 v22, v61, v6
v_and_b32 v23, v61, v7
v_mfma_f32_16x16x32_bf16 v[12:15], v[16:19], v[176:179], v[12:15]
v_and_b32 v16, v62, v4
v_and_b32 v17, v62, v5
v_and_b32 v18, v62, v6
v_and_b32 v19, v62, v7
v_mfma_f32_16x16x32_bf16 v[12:15], v[20:23], v[180:183], v[12:15]
v_and_b32 v20, v63, v4
v_and_b32 v21, v63, v5
v_and_b32 v22, v63, v6
v_and_b32 v23, v63, v7
v_mfma_f32_16x16x32_bf16 v[12:15], v[16:19], v[184:187], v[12:15]
s_nop 0
v_mfma_f32_16x16x32_bf16 v[12:15], v[20:23], v[188:191], v[12:15]
s_mov_b32 exec_hi, 0
s_nop 6
ds_write_b128 v37, v[12:15]
s_mov_b64 exec, -1
s_waitcnt lgkmcnt(0)
s_barrier
s_cmp_eq_u32 s3, 0
s_cbranch_scc0 L_p4_23
v_and_b32 v40, 31, v1
v_lshlrev_b32 v40, 4, v40
ds_read_b128 v[192:195], v40 offset:0
ds_read_b128 v[196:199], v40 offset:512
ds_read_b128 v[200:203], v40 offset:1024
ds_read_b128 v[204:207], v40 offset:1536
ds_read_b128 v[208:211], v40 offset:2048
ds_read_b128 v[212:215], v40 offset:2560
ds_read_b128 v[216:219], v40 offset:3072
ds_read_b128 v[220:223], v40 offset:3584
s_lshl_b32 s68, s4, 9
s_add_u32 s68, s68, 344064
s_waitcnt lgkmcnt(0)
v_pk_add_f32 v[192:193], v[192:193], v[196:197]
v_pk_add_f32 v[194:195], v[194:195], v[198:199]
v_pk_add_f32 v[200:201], v[200:201], v[204:205]
v_pk_add_f32 v[202:203], v[202:203], v[206:207]
v_pk_add_f32 v[208:209], v[208:209], v[212:213]
v_pk_add_f32 v[210:211], v[210:211], v[214:215]
v_pk_add_f32 v[216:217], v[216:217], v[220:221]
v_pk_add_f32 v[218:219], v[218:219], v[222:223]
v_pk_add_f32 v[192:193], v[192:193], v[200:201]
v_pk_add_f32 v[194:195], v[194:195], v[202:203]
v_pk_add_f32 v[208:209], v[208:209], v[216:217]
v_pk_add_f32 v[210:211], v[210:211], v[218:219]
v_pk_add_f32 v[192:193], v[192:193], v[208:209]
v_pk_add_f32 v[194:195], v[194:195], v[210:211]
v_perm_b32 v192, v192, v195, s62
v_perm_b32 v193, v193, v195, s63
v_perm_b32 v194, v194, v195, s64
v_mov_b32 v195, v36
s_mov_b32 exec_hi, 0
buffer_store_dwordx4 v[192:195], v40, s[8:11], s68 offen sc1
s_mov_b64 exec, -1
L_p4_23:
s_lshl_b32 s79, s4, 3
s_add_u32 s79, s79, s3
v_and_b32 v40, 31, v1
s_movk_i32 s68, 2560
v_mul_u32_u24 v40, s68, v40
v_lshrrev_b32 v41, 5, v1
v_lshl_add_u32 v40, v41, 4, v40
v_lshlrev_b32 v41, 3, v41
v_mov_b32 v42, 0
s_cmp_lt_u32 s79, 160
s_cbranch_scc0 L_pend_24
s_cmp_lt_u32 s79, 80
s_cbranch_scc0 L_pfb_25
s_lshl_b32 s76, s79, 5
s_add_u32 s76, s76, 458752
s_lshl_b32 s78, s79, 4
s_mov_b32 s81, 0
L_py_26:
buffer_load_dwordx4 v[48:51], v40, s[8:11], s76 offen sc1
s_waitcnt vmcnt(0)
v_cmp_ne_u32 s[6:7], s61, v51
s_cmp_eq_u64 s[6:7], 0
s_cbranch_scc1 L_py_26_d
s_add_u32 s81, s81, 1
s_cmp_lt_u32 s81, 20000
s_cbranch_scc0 L_py_26_d
s_sleep 2
s_branch L_py_26
L_py_26_d:
v_perm_b32 v51, v49, v48, s65
v_lshl_or_b32 v51, v50, 24, v51
v_add_f32_dpp v48, v48, v48 row_ror:8 row_mask:0xf bank_mask:0xf
v_add_f32_dpp v49, v49, v49 row_ror:8 row_mask:0xf bank_mask:0xf
v_add_f32_dpp v50, v50, v50 row_ror:8 row_mask:0xf bank_mask:0xf
v_add_f32_dpp v51, v51, v51 row_ror:8 row_mask:0xf bank_mask:0xf
v_add_f32_dpp v48, v48, v48 row_ror:4 row_mask:0xf bank_mask:0xf
v_add_f32_dpp v49, v49, v49 row_ror:4 row_mask:0xf bank_mask:0xf
v_add_f32_dpp v50, v50, v50 row_ror:4 row_mask:0xf bank_mask:0xf
v_add_f32_dpp v51, v51, v51 row_ror:4 row_mask:0xf bank_mask:0xf
v_add_f32_dpp v48, v48, v48 row_ror:2 row_mask:0xf bank_mask:0xf
v_add_f32_dpp v49, v49, v49 row_ror:2 row_mask:0xf bank_mask:0xf
v_add_f32_dpp v50, v50, v50 row_ror:2 row_mask:0xf bank_mask:0xf
v_add_f32_dpp v51, v51, v51 row_ror:2 row_mask:0xf bank_mask:0xf
v_add_f32_dpp v48, v48, v48 row_ror:1 row_mask:0xf bank_mask:0xf
v_add_f32_dpp v49, v49, v49 row_ror:1 row_mask:0xf bank_mask:0xf
v_add_f32_dpp v50, v50, v50 row_ror:1 row_mask:0xf bank_mask:0xf
v_add_f32_dpp v51, v51, v51 row_ror:1 row_mask:0xf bank_mask:0xf
v_add_f32_dpp v48, v48, v48 row_bcast:15 row_mask:0xa bank_mask:0xf
v_add_f32_dpp v49, v49, v49 row_bcast:15 row_mask:0xa bank_mask:0xf
v_add_f32_dpp v50, v50, v50 row_bcast:15 row_mask:0xa bank_mask:0xf
v_add_f32_dpp v51, v51, v51 row_bcast:15 row_mask:0xa bank_mask:0xf
v_cvt_pk_bf16_f32 v48, v48, v49
v_cvt_pk_bf16_f32 v49, v50, v51
s_mov_b32 exec_lo, 0x80000000
s_mov_b32 exec_hi, 0x80000000
buffer_store_dwordx2 v[48:49], v41, s[12:15], s78 offen
s_mov_b64 exec, -1
s_cmp_eq_u32 s79, 0
s_cbranch_scc0 L_pend_24
s_add_u32 s68, s60, 1
v_mov_b32 v40, s68
s_mov_b64 exec, 1
buffer_store_dword v40, v42, s[8:11], 0 offen sc1
s_mov_b64 exec, -1
s_branch L_pend_24
L_pfb_25:
s_sub_u32 s79, s79, 80
s_lshl_b32 s76, s79, 5
s_add_u32 s76, s76, 557056
s_lshl_b32 s78, s79, 4
s_add_u32 s78, s78, 1280
s_and_b32 s68, s79, 31
s_lshl_b32 s68, s68, 7
s_add_u32 s77, s68, 311296
s_mov_b32 s81, 0
L_pind_27:
buffer_load_dwordx4 v[48:51], v42, s[8:11], s77 offen sc1
s_waitcnt vmcnt(0)
v_cmp_ne_u32 s[6:7], s61, v51
s_cmp_eq_u64 s[6:7], 0
s_cbranch_scc1 L_pind_27_d
s_add_u32 s81, s81, 1
s_cmp_lt_u32 s81, 20000
s_cbranch_scc0 L_pind_27_d
s_sleep 4
s_branch L_pind_27
L_pind_27_d:
s_mov_b32 s81, 0
L_py_28:
buffer_load_dwordx4 v[48:51], v40, s[8:11], s76 offen sc1
s_waitcnt vmcnt(0)
v_cmp_ne_u32 s[6:7], s61, v51
s_cmp_eq_u64 s[6:7], 0
s_cbranch_scc1 L_py_28_d
s_add_u32 s81, s81, 1
s_cmp_lt_u32 s81, 20000
s_cbranch_scc0 L_py_28_d
s_branch L_py_28
L_py_28_d:
v_perm_b32 v51, v49, v48, s65
v_lshl_or_b32 v51, v50, 24, v51
v_add_f32_dpp v48, v48, v48 row_ror:8 row_mask:0xf bank_mask:0xf
v_add_f32_dpp v49, v49, v49 row_ror:8 row_mask:0xf bank_mask:0xf
v_add_f32_dpp v50, v50, v50 row_ror:8 row_mask:0xf bank_mask:0xf
v_add_f32_dpp v51, v51, v51 row_ror:8 row_mask:0xf bank_mask:0xf
v_add_f32_dpp v48, v48, v48 row_ror:4 row_mask:0xf bank_mask:0xf
v_add_f32_dpp v49, v49, v49 row_ror:4 row_mask:0xf bank_mask:0xf
v_add_f32_dpp v50, v50, v50 row_ror:4 row_mask:0xf bank_mask:0xf
v_add_f32_dpp v51, v51, v51 row_ror:4 row_mask:0xf bank_mask:0xf
v_add_f32_dpp v48, v48, v48 row_ror:2 row_mask:0xf bank_mask:0xf
v_add_f32_dpp v49, v49, v49 row_ror:2 row_mask:0xf bank_mask:0xf
v_add_f32_dpp v50, v50, v50 row_ror:2 row_mask:0xf bank_mask:0xf
v_add_f32_dpp v51, v51, v51 row_ror:2 row_mask:0xf bank_mask:0xf
v_add_f32_dpp v48, v48, v48 row_ror:1 row_mask:0xf bank_mask:0xf
v_add_f32_dpp v49, v49, v49 row_ror:1 row_mask:0xf bank_mask:0xf
v_add_f32_dpp v50, v50, v50 row_ror:1 row_mask:0xf bank_mask:0xf
v_add_f32_dpp v51, v51, v51 row_ror:1 row_mask:0xf bank_mask:0xf
v_add_f32_dpp v48, v48, v48 row_bcast:15 row_mask:0xa bank_mask:0xf
v_add_f32_dpp v49, v49, v49 row_bcast:15 row_mask:0xa bank_mask:0xf
v_add_f32_dpp v50, v50, v50 row_bcast:15 row_mask:0xa bank_mask:0xf
v_add_f32_dpp v51, v51, v51 row_bcast:15 row_mask:0xa bank_mask:0xf
v_cvt_pk_bf16_f32 v48, v48, v49
v_cvt_pk_bf16_f32 v49, v50, v51
s_mov_b32 exec_lo, 0x80000000
s_mov_b32 exec_hi, 0x80000000
buffer_store_dwordx2 v[48:49], v41, s[12:15], s78 offen
s_mov_b64 exec, -1
L_pend_24:
s_endpgm
L_Q:
s_cmp_eq_u32 s3, 7
s_cbranch_scc0 L_pf_29
s_getpc_b64 s[70:71]
L_pf_29_pc:
s_sub_u32 s70, s70, L_pf_29_pc-L_Q
s_subb_u32 s71, s71, 0
v_lshlrev_b32 v14, 7, v1
v_min_u32 v14, L_end-L_Q-4, v14
global_load_dword v32, v14, s[70:71]
L_pf_29:
s_sub_u32 s7, s7, 4
s_add_u32 s4, s6, s7
v_lshlrev_b32 v2, 4, v1
s_lshl_b32 s72, s4, 17
s_lshl_b32 s68, s3, 14
s_add_u32 s72, s72, s68
s_lshl_b32 s73, s3, 14
s_waitcnt lgkmcnt(0)
s_mov_b32 s44, s18
s_mov_b32 s45, s19
s_mov_b32 s46, 4194304
s_mov_b32 s47, 0x20000
v_xor_b32 v12, 0, v2
s_add_u32 m0, s73, 0
s_add_u32 s74, s72, 0
buffer_load_dwordx4 v12, s[44:47], s74 offen nt lds
v_xor_b32 v13, 32, v2
s_add_u32 m0, s73, 1024
s_add_u32 s74, s72, 1024
buffer_load_dwordx4 v13, s[44:47], s74 offen nt lds
v_xor_b32 v12, 64, v2
s_add_u32 m0, s73, 2048
s_add_u32 s74, s72, 2048
buffer_load_dwordx4 v12, s[44:47], s74 offen nt lds
v_xor_b32 v13, 96, v2
s_add_u32 m0, s73, 3072
s_add_u32 s74, s72, 3072
buffer_load_dwordx4 v13, s[44:47], s74 offen nt lds
v_xor_b32 v12, 0, v2
s_add_u32 m0, s73, 4096
s_add_u32 s74, s72, 4096
buffer_load_dwordx4 v12, s[44:47], s74 offen nt lds
v_xor_b32 v13, 32, v2
s_add_u32 m0, s73, 5120
s_add_u32 s74, s72, 5120
buffer_load_dwordx4 v13, s[44:47], s74 offen nt lds
v_xor_b32 v12, 64, v2
s_add_u32 m0, s73, 6144
s_add_u32 s74, s72, 6144
buffer_load_dwordx4 v12, s[44:47], s74 offen nt lds
v_xor_b32 v13, 96, v2
s_add_u32 m0, s73, 7168
s_add_u32 s74, s72, 7168
buffer_load_dwordx4 v13, s[44:47], s74 offen nt lds
v_xor_b32 v12, 128, v2
s_add_u32 m0, s73, 8192
s_add_u32 s74, s72, 8192
buffer_load_dwordx4 v12, s[44:47], s74 offen nt lds
v_xor_b32 v13, 160, v2
s_add_u32 m0, s73, 9216
s_add_u32 s74, s72, 9216
buffer_load_dwordx4 v13, s[44:47], s74 offen nt lds
v_xor_b32 v12, 192, v2
s_add_u32 m0, s73, 10240
s_add_u32 s74, s72, 10240
buffer_load_dwordx4 v12, s[44:47], s74 offen nt lds
v_xor_b32 v13, 224, v2
s_add_u32 m0, s73, 11264
s_add_u32 s74, s72, 11264
buffer_load_dwordx4 v13, s[44:47], s74 offen nt lds
v_xor_b32 v12, 128, v2
s_add_u32 m0, s73, 12288
s_add_u32 s74, s72, 12288
buffer_load_dwordx4 v12, s[44:47], s74 offen nt lds
v_xor_b32 v13, 160, v2
s_add_u32 m0, s73, 13312
s_add_u32 s74, s72, 13312
buffer_load_dwordx4 v13, s[44:47], s74 offen nt lds
v_xor_b32 v12, 192, v2
s_add_u32 m0, s73, 14336
s_add_u32 s74, s72, 14336
buffer_load_dwordx4 v12, s[44:47], s74 offen nt lds
v_xor_b32 v13, 224, v2
s_add_u32 m0, s73, 15360
s_add_u32 s74, s72, 15360
buffer_load_dwordx4 v13, s[44:47], s74 offen nt lds
s_mov_b32 s48, s26
s_mov_b32 s49, s27
s_mov_b32 s50, 5242880
s_mov_b32 s51, 0x20000
v_lshrrev_b32 v62, 4, v1
s_movk_i32 s68, 5120
v_mul_u32_u24 v62, s68, v62
v_and_b32 v63, 15, v1
v_lshl_add_u32 v62, v63, 4, v62
s_lshl_b32 s68, s4, 3
s_add_u32 s68, s68, s3
s_mul_i32 s75, s68, 20480
s_lshl_b32 s73, s3, 12
s_add_u32 s73, s73, 131072
s_add_u32 m0, s73, 0
s_add_u32 s74, s75, 0
buffer_load_dwordx4 v62, s[48:51], s74 offen nt lds
s_add_u32 m0, s73, 1024
s_add_u32 s74, s75, 256
buffer_load_dwordx4 v62, s[48:51], s74 offen nt lds
s_add_u32 m0, s73, 2048
s_add_u32 s74, s75, 512
buffer_load_dwordx4 v62, s[48:51], s74 offen nt lds
s_add_u32 m0, s73, 3072
s_add_u32 s74, s75, 768
buffer_load_dwordx4 v62, s[48:51], s74 offen nt lds
s_load_dword s60, s[42:43], 0
s_mov_b32 s8, s42
s_mov_b32 s9, s43
s_mov_b32 s10, 3145728
s_mov_b32 s11, 0x20000
s_mov_b32 s12, s38
s_mov_b32 s13, s39
s_mov_b32 s14, 2560
s_mov_b32 s15, 0x20000
v_and_b32 v12, 1, v1
v_lshlrev_b32 v12, 4, v12
v_mov_b32 v13, 0xffff
v_lshlrev_b32 v12, v12, v13
v_bfe_u32 v13, v1, 1, 2
v_cmp_eq_u32 vcc, 0, v13
s_nop 1
v_cndmask_b32 v4, 0, v12, vcc
v_cmp_eq_u32 vcc, 1, v13
s_nop 1
v_cndmask_b32 v5, 0, v12, vcc
v_cmp_eq_u32 vcc, 2, v13
s_nop 1
v_cndmask_b32 v6, 0, v12, vcc
v_cmp_eq_u32 vcc, 3, v13
s_nop 1
v_cndmask_b32 v7, 0, v12, vcc
v_and_b32 v12, 3, v1
v_lshlrev_b32 v12, 1, v12
v_and_b32 v13, 8, v1
v_or_b32 v12, v12, v13
v_lshrrev_b32 v13, 4, v1
v_xor_b32 v12, v12, v13
v_lshlrev_b32 v12, 4, v12
v_xor_b32 v8, 0, v12
v_xor_b32 v9, 64, v12
v_xor_b32 v10, 128, v12
v_xor_b32 v11, 192, v12
v_and_b32 v14, 15, v1
s_and_b32 s68, s3, 3
s_lshl_b32 s68, s68, 15
v_lshl_add_u32 v15, v14, 10, s68
v_add_u32 v24, v15, v8
v_add_u32 v25, v15, v9
v_add_u32 v26, v15, v10
v_add_u32 v27, v15, v11
v_bfe_u32 v12, v1, 2, 2
v_bfe_u32 v13, v1, 4, 1
v_lshlrev_b32 v13, 3, v13
v_lshl_or_b32 v13, v12, 1, v13
v_bfe_u32 v15, v1, 1, 1
v_xor_b32 v13, v13, v15
s_and_b32 s68, s3, 1
s_lshl_b32 s68, s68, 3
v_xor_b32 v13, s68, v13
v_lshrrev_b32 v15, 4, v1
v_lshl_add_u32 v12, v15, 3, v12
v_lshlrev_b32 v12, 10, v12
v_and_b32 v15, 1, v1
v_lshl_add_u32 v12, v15, 3, v12
s_lshr_b32 s68, s3, 1
s_lshl_b32 s68, s68, 8
v_add_u32 v12, s68, v12
v_xor_b32 v28, 0, v13
v_lshl_add_u32 v28, v28, 4, v12
v_xor_b32 v29, 2, v13
v_lshl_add_u32 v29, v29, 4, v12
v_xor_b32 v30, 4, v13
v_lshl_add_u32 v30, v30, 4, v12
v_xor_b32 v31, 6, v13
v_lshl_add_u32 v31, v31, 4, v12
s_waitcnt vmcnt(4)
s_waitcnt lgkmcnt(0)
s_mul_i32 s61, s60, 0x9E3779B1
s_add_u32 s61, s61, 0x85EBCA6B
v_mov_b32 v3, s61
s_barrier
ds_read_b128 v[64:67], v24 offset:0
ds_read_b128 v[68:71], v25 offset:0
ds_read_b128 v[72:75], v26 offset:0
ds_read_b128 v[76:79], v27 offset:0
ds_read_b128 v[80:83], v24 offset:256
ds_read_b128 v[84:87], v25 offset:256
ds_read_b128 v[88:91], v26 offset:256
ds_read_b128 v[92:95], v27 offset:256
ds_read_b128 v[96:99], v24 offset:512
ds_read_b128 v[100:103], v25 offset:512
ds_read_b128 v[104:107], v26 offset:512
ds_read_b128 v[108:111], v27 offset:512
ds_read_b128 v[112:115], v24 offset:768
ds_read_b128 v[116:119], v25 offset:768
ds_read_b128 v[120:123], v26 offset:768
ds_read_b128 v[124:127], v27 offset:768
s_waitcnt lgkmcnt(8)
ds_read_b128 v[128:131], v24 offset:16384
ds_read_b128 v[132:135], v25 offset:16384
ds_read_b128 v[136:139], v26 offset:16384
ds_read_b128 v[140:143], v27 offset:16384
ds_read_b128 v[144:147], v24 offset:16640
ds_read_b128 v[148:151], v25 offset:16640
ds_read_b128 v[152:155], v26 offset:16640
ds_read_b128 v[156:159], v27 offset:16640
ds_read_b128 v[160:163], v24 offset:16896
ds_read_b128 v[164:167], v25 offset:16896
ds_read_b128 v[168:171], v26 offset:16896
ds_read_b128 v[172:175], v27 offset:16896
ds_read_b128 v[176:179], v24 offset:17152
ds_read_b128 v[180:183], v25 offset:17152
ds_read_b128 v[184:187], v26 offset:17152
ds_read_b128 v[188:191], v27 offset:17152
s_waitcnt lgkmcnt(8)
ds_read_b64_tr_b16 v[192:193], v28 offset:0
ds_read_b64_tr_b16 v[194:195], v28 offset:4096
ds_read_b64_tr_b16 v[196:197], v28 offset:32768
ds_read_b64_tr_b16 v[198:199], v28 offset:36864
s_waitcnt lgkmcnt(8)
ds_read_b64_tr_b16 v[208:209], v29 offset:0
ds_read_b64_tr_b16 v[210:211], v29 offset:4096
ds_read_b64_tr_b16 v[212:213], v29 offset:32768
ds_read_b64_tr_b16 v[214:215], v29 offset:36864
s_waitcnt lgkmcnt(8)
ds_read_b64_tr_b16 v[224:225], v30 offset:0
ds_read_b64_tr_b16 v[226:227], v30 offset:4096
ds_read_b64_tr_b16 v[228:229], v30 offset:32768
ds_read_b64_tr_b16 v[230:231], v30 offset:36864
s_waitcnt lgkmcnt(8)
ds_read_b64_tr_b16 v[240:241], v31 offset:0
ds_read_b64_tr_b16 v[242:243], v31 offset:4096
ds_read_b64_tr_b16 v[244:245], v31 offset:32768
ds_read_b64_tr_b16 v[246:247], v31 offset:36864
s_waitcnt lgkmcnt(8)
v_add_u32 v28, 0x10000, v28
v_add_u32 v29, 0x10000, v29
v_add_u32 v30, 0x10000, v30
v_add_u32 v31, 0x10000, v31
ds_read_b64_tr_b16 v[200:201], v28 offset:0
ds_read_b64_tr_b16 v[202:203], v28 offset:4096
ds_read_b64_tr_b16 v[204:205], v28 offset:32768
ds_read_b64_tr_b16 v[206:207], v28 offset:36864
s_waitcnt lgkmcnt(8)
ds_read_b64_tr_b16 v[216:217], v29 offset:0
ds_read_b64_tr_b16 v[218:219], v29 offset:4096
ds_read_b64_tr_b16 v[220:221], v29 offset:32768
ds_read_b64_tr_b16 v[222:223], v29 offset:36864
s_waitcnt lgkmcnt(8)
ds_read_b64_tr_b16 v[232:233], v30 offset:0
ds_read_b64_tr_b16 v[234:235], v30 offset:4096
ds_read_b64_tr_b16 v[236:237], v30 offset:32768
ds_read_b64_tr_b16 v[238:239], v30 offset:36864
s_waitcnt lgkmcnt(8)
ds_read_b64_tr_b16 v[248:249], v31 offset:0
ds_read_b64_tr_b16 v[250:251], v31 offset:4096
ds_read_b64_tr_b16 v[252:253], v31 offset:32768
ds_read_b64_tr_b16 v[254:255], v31 offset:36864
s_waitcnt lgkmcnt(8)
s_waitcnt lgkmcnt(0)
s_barrier
v_lshrrev_b32 v62, 4, v1
s_movk_i32 s68, 5120
v_mul_u32_u24 v62, s68, v62
v_lshl_add_u32 v62, v14, 4, v62
s_lshl_b32 s68, s4, 3
s_add_u32 s68, s68, s3
s_mul_i32 s72, s68, 20480
s_lshl_b32 s73, s3, 12
s_add_u32 s73, s73, 98304
s_add_u32 m0, s73, 0
s_add_u32 s74, s72, 1024
buffer_load_dwordx4 v62, s[48:51], s74 offen nt lds
s_add_u32 m0, s73, 1024
s_add_u32 s74, s72, 1280
buffer_load_dwordx4 v62, s[48:51], s74 offen nt lds
s_add_u32 m0, s73, 2048
s_add_u32 s74, s72, 1536
buffer_load_dwordx4 v62, s[48:51], s74 offen nt lds
s_add_u32 m0, s73, 3072
s_add_u32 s74, s72, 1792
buffer_load_dwordx4 v62, s[48:51], s74 offen nt lds
s_cmp_eq_u32 s3, 7
s_cbranch_scc0 L_pf_30
s_getpc_b64 s[70:71]
L_pf_30_pc:
s_add_u32 s70, s70, L_Q_t-L_pf_30_pc
s_addc_u32 s71, s71, 0
v_lshlrev_b32 v15, 7, v1
v_min_u32 v15, L_end-L_Q_t-4, v15
global_load_dword v63, v15, s[70:71]
L_pf_30:
L_Q_t:
s_lshl_b32 s76, s3, 13
s_add_u32 s76, s76, 393216
s_add_u32 s77, s76, 4096
v_mov_b32 v12, 0
s_mov_b32 s81, 0
L_qind_31:
buffer_load_dwordx4 v[32:35], v12, s[8:11], s76 offen sc1
s_waitcnt vmcnt(0)
v_cmp_ne_u32 s[6:7], s61, v35
s_cmp_eq_u64 s[6:7], 0
s_cbranch_scc1 L_qind_31_d
s_add_u32 s81, s81, 1
s_cmp_lt_u32 s81, 20000
s_cbranch_scc0 L_qind_31_d
s_sleep 2
s_branch L_qind_31
L_qind_31_d:
s_mov_b32 s81, 0
L_qabs_32:
buffer_load_dwordx4 v[32:35], v2, s[8:11], s76 offen offset:0 sc1
buffer_load_dwordx4 v[36:39], v2, s[8:11], s76 offen offset:1024 sc1
buffer_load_dwordx4 v[40:43], v2, s[8:11], s76 offen offset:2048 sc1
buffer_load_dwordx4 v[44:47], v2, s[8:11], s76 offen offset:3072 sc1
buffer_load_dwordx4 v[48:51], v2, s[8:11], s77 offen offset:0 sc1
buffer_load_dwordx4 v[52:55], v2, s[8:11], s77 offen offset:1024 sc1
buffer_load_dwordx4 v[56:59], v2, s[8:11], s77 offen offset:2048 sc1
buffer_load_dwordx4 v[60:63], v2, s[8:11], s77 offen offset:3072 sc1
s_waitcnt vmcnt(0)
v_cmp_ne_u32 s[6:7], s61, v35
v_cmp_ne_u32 vcc, s61, v39
s_or_b64 s[6:7], s[6:7], vcc
v_cmp_ne_u32 vcc, s61, v43
s_or_b64 s[6:7], s[6:7], vcc
v_cmp_ne_u32 vcc, s61, v47
s_or_b64 s[6:7], s[6:7], vcc
v_cmp_ne_u32 vcc, s61, v51
s_or_b64 s[6:7], s[6:7], vcc
v_cmp_ne_u32 vcc, s61, v55
s_or_b64 s[6:7], s[6:7], vcc
v_cmp_ne_u32 vcc, s61, v59
s_or_b64 s[6:7], s[6:7], vcc
v_cmp_ne_u32 vcc, s61, v63
s_or_b64 s[6:7], s[6:7], vcc
s_cmp_eq_u64 s[6:7], 0
s_cbranch_scc1 L_qabs_32_d
s_add_u32 s81, s81, 1
s_cmp_lt_u32 s81, 20000
s_cbranch_scc0 L_qabs_32_d
s_branch L_qabs_32
L_qabs_32_d:
s_bfe_u32 s68, s3, 0x10001
s_lshl_b32 s68, s68, 7
v_lshlrev_b32 v12, 3, v1
v_xor_b32 v12, s68, v12
s_lshl_b32 s68, s3, 12
v_xor_b32 v24, 0, v12
v_add_u32 v24, s68, v24
v_xor_b32 v25, 32, v12
v_add_u32 v25, s68, v25
v_xor_b32 v26, 64, v12
v_add_u32 v26, s68, v26
v_xor_b32 v27, 96, v12
v_add_u32 v27, s68, v27
v_perm_b32 v35, v33, v32, s65
v_lshl_or_b32 v35, v34, 24, v35
v_cvt_pk_bf16_f32 v32, v32, v33
v_cvt_pk_bf16_f32 v33, v34, v35
ds_write_b64 v24, v[32:33] offset:0
v_perm_b32 v39, v37, v36, s65
v_lshl_or_b32 v39, v38, 24, v39
v_cvt_pk_bf16_f32 v36, v36, v37
v_cvt_pk_bf16_f32 v37, v38, v39
ds_write_b64 v24, v[36:37] offset:512
v_perm_b32 v43, v41, v40, s65
v_lshl_or_b32 v43, v42, 24, v43
v_cvt_pk_bf16_f32 v40, v40, v41
v_cvt_pk_bf16_f32 v41, v42, v43
ds_write_b64 v25, v[40:41] offset:1024
v_perm_b32 v47, v45, v44, s65
v_lshl_or_b32 v47, v46, 24, v47
v_cvt_pk_bf16_f32 v44, v44, v45
v_cvt_pk_bf16_f32 v45, v46, v47
ds_write_b64 v25, v[44:45] offset:1536
v_perm_b32 v51, v49, v48, s65
v_lshl_or_b32 v51, v50, 24, v51
v_cvt_pk_bf16_f32 v48, v48, v49
v_cvt_pk_bf16_f32 v49, v50, v51
ds_write_b64 v26, v[48:49] offset:2048
v_perm_b32 v55, v53, v52, s65
v_lshl_or_b32 v55, v54, 24, v55
v_cvt_pk_bf16_f32 v52, v52, v53
v_cvt_pk_bf16_f32 v53, v54, v55
ds_write_b64 v26, v[52:53] offset:2560
v_perm_b32 v59, v57, v56, s65
v_lshl_or_b32 v59, v58, 24, v59
v_cvt_pk_bf16_f32 v56, v56, v57
v_cvt_pk_bf16_f32 v57, v58, v59
ds_write_b64 v27, v[56:57] offset:3072
v_perm_b32 v63, v61, v60, s65
v_lshl_or_b32 v63, v62, 24, v63
v_cvt_pk_bf16_f32 v60, v60, v61
v_cvt_pk_bf16_f32 v61, v62, v63
ds_write_b64 v27, v[60:61] offset:3584
s_lshr_b32 s68, s3, 2
s_lshl_b32 s68, s68, 14
v_lshl_add_u32 v15, v14, 10, s68
v_add_u32 v28, v15, v8
v_add_u32 v29, v15, v9
v_add_u32 v30, v15, v10
v_add_u32 v31, v15, v11
s_waitcnt lgkmcnt(0)
s_barrier
ds_read_b128 v[32:35], v28 offset:0
ds_read_b128 v[36:39], v29 offset:0
ds_read_b128 v[40:43], v30 offset:0
ds_read_b128 v[44:47], v31 offset:0
ds_read_b128 v[48:51], v28 offset:256
ds_read_b128 v[52:55], v29 offset:256
ds_read_b128 v[56:59], v30 offset:256
ds_read_b128 v[60:63], v31 offset:256
s_waitcnt lgkmcnt(7)
v_mfma_f32_16x16x32_bf16 v[16:19], v[64:67], v[32:35], 0
v_mfma_f32_16x16x32_bf16 v[20:23], v[128:131], v[32:35], 0
ds_read_b128 v[32:35], v28 offset:512
s_waitcnt lgkmcnt(7)
v_mfma_f32_16x16x32_bf16 v[16:19], v[68:71], v[36:39], v[16:19]
v_mfma_f32_16x16x32_bf16 v[20:23], v[132:135], v[36:39], v[20:23]
ds_read_b128 v[36:39], v29 offset:512
s_waitcnt lgkmcnt(7)
v_mfma_f32_16x16x32_bf16 v[16:19], v[72:75], v[40:43], v[16:19]
v_mfma_f32_16x16x32_bf16 v[20:23], v[136:139], v[40:43], v[20:23]
ds_read_b128 v[40:43], v30 offset:512
s_waitcnt lgkmcnt(7)
v_mfma_f32_16x16x32_bf16 v[16:19], v[76:79], v[44:47], v[16:19]
v_mfma_f32_16x16x32_bf16 v[20:23], v[140:143], v[44:47], v[20:23]
ds_read_b128 v[44:47], v31 offset:512
s_waitcnt lgkmcnt(7)
v_mfma_f32_16x16x32_bf16 v[16:19], v[80:83], v[48:51], v[16:19]
v_mfma_f32_16x16x32_bf16 v[20:23], v[144:147], v[48:51], v[20:23]
ds_read_b128 v[48:51], v28 offset:768
s_waitcnt lgkmcnt(7)
v_mfma_f32_16x16x32_bf16 v[16:19], v[84:87], v[52:55], v[16:19]
v_mfma_f32_16x16x32_bf16 v[20:23], v[148:151], v[52:55], v[20:23]
ds_read_b128 v[52:55], v29 offset:768
s_waitcnt lgkmcnt(7)
v_mfma_f32_16x16x32_bf16 v[16:19], v[88:91], v[56:59], v[16:19]
v_mfma_f32_16x16x32_bf16 v[20:23], v[152:155], v[56:59], v[20:23]
ds_read_b128 v[56:59], v30 offset:768
s_waitcnt lgkmcnt(7)
v_mfma_f32_16x16x32_bf16 v[16:19], v[92:95], v[60:63], v[16:19]
v_mfma_f32_16x16x32_bf16 v[20:23], v[156:159], v[60:63], v[20:23]
ds_read_b128 v[60:63], v31 offset:768
s_waitcnt lgkmcnt(7)
v_mfma_f32_16x16x32_bf16 v[16:19], v[96:99], v[32:35], v[16:19]
v_mfma_f32_16x16x32_bf16 v[20:23], v[160:163], v[32:35], v[20:23]
s_waitcnt lgkmcnt(6)
v_mfma_f32_16x16x32_bf16 v[16:19], v[100:103], v[36:39], v[16:19]
v_mfma_f32_16x16x32_bf16 v[20:23], v[164:167], v[36:39], v[20:23]
s_waitcnt lgkmcnt(5)
v_mfma_f32_16x16x32_bf16 v[16:19], v[104:107], v[40:43], v[16:19]
v_mfma_f32_16x16x32_bf16 v[20:23], v[168:171], v[40:43], v[20:23]
s_waitcnt lgkmcnt(4)
v_mfma_f32_16x16x32_bf16 v[16:19], v[108:111], v[44:47], v[16:19]
v_mfma_f32_16x16x32_bf16 v[20:23], v[172:175], v[44:47], v[20:23]
s_waitcnt lgkmcnt(3)
v_mfma_f32_16x16x32_bf16 v[16:19], v[112:115], v[48:51], v[16:19]
v_mfma_f32_16x16x32_bf16 v[20:23], v[176:179], v[48:51], v[20:23]
s_waitcnt lgkmcnt(2)
v_mfma_f32_16x16x32_bf16 v[16:19], v[116:119], v[52:55], v[16:19]
v_mfma_f32_16x16x32_bf16 v[20:23], v[180:183], v[52:55], v[20:23]
s_waitcnt lgkmcnt(1)
v_mfma_f32_16x16x32_bf16 v[16:19], v[120:123], v[56:59], v[16:19]
v_mfma_f32_16x16x32_bf16 v[20:23], v[184:187], v[56:59], v[20:23]
s_waitcnt lgkmcnt(0)
v_mfma_f32_16x16x32_bf16 v[16:19], v[124:127], v[60:63], v[16:19]
v_mfma_f32_16x16x32_bf16 v[20:23], v[188:191], v[60:63], v[20:23]
s_nop 6
v_max3_f32 v12, v16, v17, v18
v_max3_f32 v12, v12, v19, v20
v_max3_f32 v12, v12, v21, v22
v_max_f32 v12, v12, v23
v_mov_b32 v13, v12
s_nop 1
v_permlane16_swap_b32 v12, v13
v_max_f32 v12, v12, v13
v_mov_b32 v13, v12
s_nop 1
v_permlane32_swap_b32 v12, v13
v_max_f32 v12, v12, v13
s_lshr_b32 s68, s3, 2
s_lshl_b32 s68, s68, 8
v_lshl_add_u32 v24, v14, 4, s68
s_and_b32 s69, s3, 3
s_lshl_b32 s69, s69, 2
v_add_u32 v25, s69, v24
s_mov_b32 exec_hi, 0
s_mov_b32 exec_lo, 0xffff
ds_write_b32 v25, v12 offset:32768
s_mov_b64 exec, -1
s_waitcnt lgkmcnt(0)
s_barrier
ds_read_b128 v[32:35], v24 offset:32768
v_and_b32 v26, 3, v1
v_lshlrev_b32 v26, 1, v26
v_and_b32 v27, 8, v1
v_or_b32 v26, v26, v27
v_lshrrev_b32 v27, 5, v1
v_xor_b32 v26, v26, v27
s_and_b32 s69, s3, 3
s_lshl_b32 s69, s69, 2
v_xor_b32 v26, s69, v26
v_bfe_u32 v27, v1, 4, 1
v_lshlrev_b32 v27, 3, v27
v_lshl_add_u32 v27, v14, 8, v27
s_lshl_b32 s68, s68, 4
v_add_u32 v27, s68, v27
v_lshl_add_u32 v28, v26, 4, v27
v_xor_b32 v26, 2, v26
v_lshl_add_u32 v29, v26, 4, v27
s_waitcnt lgkmcnt(0)
v_max3_f32 v12, v32, v33, v34
v_max_f32 v12, v12, v35
v_mul_f32 v12, s80, v12
v_fma_f32 v16, v16, s80, -v12
v_fma_f32 v17, v17, s80, -v12
v_fma_f32 v18, v18, s80, -v12
v_fma_f32 v19, v19, s80, -v12
v_fma_f32 v20, v20, s80, -v12
v_fma_f32 v21, v21, s80, -v12
v_fma_f32 v22, v22, s80, -v12
v_fma_f32 v23, v23, s80, -v12
v_exp_f32 v16, v16
v_exp_f32 v17, v17
v_exp_f32 v18, v18
v_exp_f32 v19, v19
v_exp_f32 v20, v20
v_exp_f32 v21, v21
v_exp_f32 v22, v22
v_exp_f32 v23, v23
v_add_f32 v15, v16, v17
v_add_f32 v15, v15, v18
v_add_f32 v15, v15, v19
v_add_f32 v15, v15, v20
v_add_f32 v15, v15, v21
v_add_f32 v15, v15, v22
v_add_f32 v15, v15, v23
v_cvt_pk_bf16_f32 v16, v16, v17
v_cvt_pk_bf16_f32 v17, v18, v19
ds_write_b64 v28, v[16:17] offset:36864
v_cvt_pk_bf16_f32 v20, v20, v21
v_cvt_pk_bf16_f32 v21, v22, v23
ds_write_b64 v29, v[20:21] offset:36864
v_mov_b32 v13, v15
s_nop 1
v_permlane16_swap_b32 v15, v13
v_add_f32 v15, v15, v13
v_mov_b32 v13, v15
s_nop 1
v_permlane32_swap_b32 v15, v13
v_add_f32 v15, v15, v13
s_mov_b32 exec_hi, 0
s_mov_b32 exec_lo, 0xffff
ds_write_b32 v25, v15 offset:33280
s_mov_b64 exec, -1
s_waitcnt lgkmcnt(0)
s_barrier
v_lshlrev_b32 v15, 8, v14
v_add_u32 v24, v15, v8
v_add_u32 v25, v15, v9
v_add_u32 v26, v15, v10
v_add_u32 v27, v15, v11
ds_read_b128 v[32:35], v24 offset:36864
ds_read_b128 v[36:39], v25 offset:36864
ds_read_b128 v[40:43], v26 offset:36864
ds_read_b128 v[44:47], v27 offset:36864
ds_read_b128 v[48:51], v24 offset:40960
ds_read_b128 v[52:55], v25 offset:40960
ds_read_b128 v[56:59], v26 offset:40960
ds_read_b128 v[60:63], v27 offset:40960
s_waitcnt lgkmcnt(4)
v_mfma_f32_16x16x32_bf16 v[64:67], v[192:195], v[32:35], 0
v_mfma_f32_16x16x32_bf16 v[68:71], v[208:211], v[32:35], 0
v_mfma_f32_16x16x32_bf16 v[72:75], v[224:227], v[32:35], 0
v_mfma_f32_16x16x32_bf16 v[76:79], v[240:243], v[32:35], 0
v_mfma_f32_16x16x32_bf16 v[64:67], v[196:199], v[36:39], v[64:67]
v_mfma_f32_16x16x32_bf16 v[68:71], v[212:215], v[36:39], v[68:71]
v_mfma_f32_16x16x32_bf16 v[72:75], v[228:231], v[36:39], v[72:75]
v_mfma_f32_16x16x32_bf16 v[76:79], v[244:247], v[36:39], v[76:79]
v_mfma_f32_16x16x32_bf16 v[64:67], v[200:203], v[40:43], v[64:67]
v_mfma_f32_16x16x32_bf16 v[68:71], v[216:219], v[40:43], v[68:71]
v_mfma_f32_16x16x32_bf16 v[72:75], v[232:235], v[40:43], v[72:75]
v_mfma_f32_16x16x32_bf16 v[76:79], v[248:251], v[40:43], v[76:79]
v_mfma_f32_16x16x32_bf16 v[64:67], v[204:207], v[44:47], v[64:67]
v_mfma_f32_16x16x32_bf16 v[68:71], v[220:223], v[44:47], v[68:71]
v_mfma_f32_16x16x32_bf16 v[72:75], v[236:239], v[44:47], v[72:75]
v_mfma_f32_16x16x32_bf16 v[76:79], v[252:255], v[44:47], v[76:79]
s_waitcnt lgkmcnt(0)
v_mfma_f32_16x16x32_bf16 v[80:83], v[192:195], v[48:51], 0
v_mfma_f32_16x16x32_bf16 v[84:87], v[208:211], v[48:51], 0
v_mfma_f32_16x16x32_bf16 v[88:91], v[224:227], v[48:51], 0
v_mfma_f32_16x16x32_bf16 v[92:95], v[240:243], v[48:51], 0
v_mfma_f32_16x16x32_bf16 v[80:83], v[196:199], v[52:55], v[80:83]
v_mfma_f32_16x16x32_bf16 v[84:87], v[212:215], v[52:55], v[84:87]
v_mfma_f32_16x16x32_bf16 v[88:91], v[228:231], v[52:55], v[88:91]
v_mfma_f32_16x16x32_bf16 v[92:95], v[244:247], v[52:55], v[92:95]
v_mfma_f32_16x16x32_bf16 v[80:83], v[200:203], v[56:59], v[80:83]
v_mfma_f32_16x16x32_bf16 v[84:87], v[216:219], v[56:59], v[84:87]
v_mfma_f32_16x16x32_bf16 v[88:91], v[232:235], v[56:59], v[88:91]
v_mfma_f32_16x16x32_bf16 v[92:95], v[248:251], v[56:59], v[92:95]
v_mfma_f32_16x16x32_bf16 v[80:83], v[204:207], v[60:63], v[80:83]
v_mfma_f32_16x16x32_bf16 v[84:87], v[220:223], v[60:63], v[84:87]
v_mfma_f32_16x16x32_bf16 v[88:91], v[236:239], v[60:63], v[88:91]
v_mfma_f32_16x16x32_bf16 v[92:95], v[252:255], v[60:63], v[92:95]
v_lshrrev_b32 v24, 4, v1
v_and_b32 v25, 7, v1
v_lshlrev_b32 v25, 1, v25
v_xor_b32 v25, v25, v24
s_lshl_b32 s68, s3, 12
s_add_u32 s68, s68, 65536
v_lshl_add_u32 v26, v14, 7, s68
v_xor_b32 v28, 0, v25
v_lshl_add_u32 v28, v28, 3, v26
v_xor_b32 v29, 4, v25
v_lshl_add_u32 v29, v29, 3, v26
v_xor_b32 v30, 8, v25
v_lshl_add_u32 v30, v30, 3, v26
v_xor_b32 v31, 12, v25
v_lshl_add_u32 v31, v31, 3, v26
v_cvt_pk_bf16_f32 v64, v64, v65
v_cvt_pk_bf16_f32 v65, v66, v67
ds_write_b64 v28, v[64:65] offset:0
v_cvt_pk_bf16_f32 v68, v68, v69
v_cvt_pk_bf16_f32 v69, v70, v71
ds_write_b64 v29, v[68:69] offset:0
v_cvt_pk_bf16_f32 v72, v72, v73
v_cvt_pk_bf16_f32 v73, v74, v75
ds_write_b64 v30, v[72:73] offset:0
v_cvt_pk_bf16_f32 v76, v76, v77
v_cvt_pk_bf16_f32 v77, v78, v79
ds_write_b64 v31, v[76:77] offset:0
v_cvt_pk_bf16_f32 v80, v80, v81
v_cvt_pk_bf16_f32 v81, v82, v83
ds_write_b64 v28, v[80:81] offset:2048
v_cvt_pk_bf16_f32 v84, v84, v85
v_cvt_pk_bf16_f32 v85, v86, v87
ds_write_b64 v29, v[84:85] offset:2048
v_cvt_pk_bf16_f32 v88, v88, v89
v_cvt_pk_bf16_f32 v89, v90, v91
ds_write_b64 v30, v[88:89] offset:2048
v_cvt_pk_bf16_f32 v92, v92, v93
v_cvt_pk_bf16_f32 v93, v94, v95
ds_write_b64 v31, v[92:93] offset:2048
v_lshrrev_b32 v24, 3, v1
v_and_b32 v25, 7, v1
v_xor_b32 v26, v24, v25
v_lshlrev_b32 v26, 4, v26
v_lshl_add_u32 v26, v24, 7, v26
v_add_u32 v26, s68, v26
v_lshlrev_b32 v25, 4, v25
v_lshl_add_u32 v25, v24, 15, v25
s_lshl_b32 s76, s4, 10
s_lshl_b32 s69, s3, 7
s_add_u32 s76, s76, s69
s_add_u32 s76, s76, 1048576
s_waitcnt lgkmcnt(0)
ds_read_b128 v[32:35], v26 offset:0
ds_read_b128 v[36:39], v26 offset:1024
ds_read_b128 v[40:43], v26 offset:2048
ds_read_b128 v[44:47], v26 offset:3072
s_waitcnt lgkmcnt(3)
buffer_store_dwordx4 v[32:35], v25, s[8:11], s76 offen sc1
s_add_u32 s76, s76, 0x40000
s_waitcnt lgkmcnt(2)
buffer_store_dwordx4 v[36:39], v25, s[8:11], s76 offen sc1
s_add_u32 s76, s76, 0x40000
s_waitcnt lgkmcnt(1)
buffer_store_dwordx4 v[40:43], v25, s[8:11], s76 offen sc1
s_add_u32 s76, s76, 0x40000
s_waitcnt lgkmcnt(0)
buffer_store_dwordx4 v[44:47], v25, s[8:11], s76 offen sc1
s_waitcnt vmcnt(0)
s_barrier
s_cmp_eq_u32 s3, 0
s_cbranch_scc0 L_q1_33
v_and_b32 v12, 31, v1
v_lshlrev_b32 v13, 4, v12
ds_read_b128 v[192:195], v13 offset:32768
ds_read_b128 v[196:199], v13 offset:33280
v_lshlrev_b32 v12, 9, v12
s_lshl_b32 s68, s4, 4
s_add_u32 s68, s68, 327680
s_waitcnt lgkmcnt(0)
v_max3_f32 v192, v192, v193, v194
v_max_f32 v192, v192, v195
v_mul_f32 v192, s80, v192
v_pk_add_f32 v[196:197], v[196:197], v[198:199]
v_add_f32 v193, v196, v197
v_mov_b32 v194, 0
v_mov_b32 v195, v3
s_mov_b32 exec_hi, 0
buffer_store_dwordx4 v[192:195], v12, s[8:11], s68 offen sc1
s_mov_b64 exec, -1
L_q1_33:
s_barrier
v_lshrrev_b32 v62, 4, v1
s_movk_i32 s68, 5120
v_mul_u32_u24 v62, s68, v62
v_lshl_add_u32 v62, v14, 4, v62
s_add_u32 s73, s72, 1280
buffer_load_dwordx4 v[128:131], v62, s[48:51], s73 offen offset:768 nt
s_add_u32 s73, s72, 1280
buffer_load_dwordx4 v[132:135], v62, s[48:51], s73 offen offset:1024 nt
s_add_u32 s73, s72, 2560
buffer_load_dwordx4 v[136:139], v62, s[48:51], s73 offen offset:0 nt
s_add_u32 s73, s72, 2560
buffer_load_dwordx4 v[140:143], v62, s[48:51], s73 offen offset:256 nt
s_add_u32 s73, s72, 2560
buffer_load_dwordx4 v[144:147], v62, s[48:51], s73 offen offset:512 nt
s_add_u32 s73, s72, 2560
buffer_load_dwordx4 v[148:151], v62, s[48:51], s73 offen offset:768 nt
s_add_u32 s73, s72, 2560
buffer_load_dwordx4 v[152:155], v62, s[48:51], s73 offen offset:1024 nt
s_add_u32 s73, s72, 3840
buffer_load_dwordx4 v[156:159], v62, s[48:51], s73 offen offset:0 nt
s_add_u32 s73, s72, 3840
buffer_load_dwordx4 v[160:163], v62, s[48:51], s73 offen offset:256 nt
s_add_u32 s73, s72, 3840
buffer_load_dwordx4 v[164:167], v62, s[48:51], s73 offen offset:512 nt
s_add_u32 s73, s72, 3840
buffer_load_dwordx4 v[168:171], v62, s[48:51], s73 offen offset:768 nt
s_add_u32 s73, s72, 3840
buffer_load_dwordx4 v[172:175], v62, s[48:51], s73 offen offset:1024 nt
s_lshl_b32 s68, s3, 12
s_add_u32 s68, s68, 98304
v_add_u32 v63, s68, v2
ds_read_b128 v[96:99], v63 offset:32768
ds_read_b128 v[100:103], v63 offset:33792
ds_read_b128 v[104:107], v63 offset:34816
ds_read_b128 v[108:111], v63 offset:35840
ds_read_b128 v[112:115], v63 offset:0
ds_read_b128 v[116:119], v63 offset:1024
ds_read_b128 v[120:123], v63 offset:2048
ds_read_b128 v[124:127], v63 offset:3072
v_lshrrev_b32 v12, 4, v1
v_lshlrev_b32 v12, 4, v12
s_lshl_b32 s76, s4, 9
s_lshl_b32 s68, s3, 6
s_add_u32 s76, s76, s68
s_add_u32 s76, s76, 344064
s_mov_b32 s81, 0
L_qcf_34:
buffer_load_dwordx4 v[32:35], v12, s[8:11], s76 offen sc1
s_waitcnt vmcnt(0)
v_cmp_ne_u32 s[6:7], s61, v35
s_cmp_eq_u64 s[6:7], 0
s_cbranch_scc1 L_qcf_34_d
s_add_u32 s81, s81, 1
s_cmp_lt_u32 s81, 20000
s_cbranch_scc0 L_qcf_34_d
s_sleep 2
s_branch L_qcf_34
L_qcf_34_d:
s_waitcnt lgkmcnt(0)
v_perm_b32 v35, v33, v32, s65
v_lshl_or_b32 v35, v34, 24, v35
v_cvt_pk_bf16_f32 v32, v32, v32
v_cvt_pk_bf16_f32 v33, v33, v33
v_cvt_pk_bf16_f32 v34, v34, v34
v_cvt_pk_bf16_f32 v35, v35, v35
v_and_b32 v24, v32, v4
v_and_b32 v25, v32, v5
v_and_b32 v26, v32, v6
v_and_b32 v27, v32, v7
v_and_b32 v28, v33, v4
v_and_b32 v29, v33, v5
v_and_b32 v30, v33, v6
v_and_b32 v31, v33, v7
v_mfma_f32_16x16x32_bf16 v[176:179], v[24:27], v[96:99], 0
v_mfma_f32_16x16x32_bf16 v[180:183], v[24:27], v[100:103], 0
v_mfma_f32_16x16x32_bf16 v[184:187], v[24:27], v[104:107], 0
v_mfma_f32_16x16x32_bf16 v[188:191], v[24:27], v[108:111], 0
v_mfma_f32_16x16x32_bf16 v[192:195], v[24:27], v[112:115], 0
v_and_b32 v24, v34, v4
v_and_b32 v25, v34, v5
v_and_b32 v26, v34, v6
v_and_b32 v27, v34, v7
v_mfma_f32_16x16x32_bf16 v[176:179], v[28:31], v[116:119], v[176:179]
v_mfma_f32_16x16x32_bf16 v[180:183], v[28:31], v[120:123], v[180:183]
v_mfma_f32_16x16x32_bf16 v[184:187], v[28:31], v[124:127], v[184:187]
v_mfma_f32_16x16x32_bf16 v[188:191], v[28:31], v[128:131], v[188:191]
v_mfma_f32_16x16x32_bf16 v[192:195], v[28:31], v[132:135], v[192:195]
v_and_b32 v28, v35, v4
v_and_b32 v29, v35, v5
v_and_b32 v30, v35, v6
v_and_b32 v31, v35, v7
v_mfma_f32_16x16x32_bf16 v[176:179], v[24:27], v[136:139], v[176:179]
v_mfma_f32_16x16x32_bf16 v[180:183], v[24:27], v[140:143], v[180:183]
v_mfma_f32_16x16x32_bf16 v[184:187], v[24:27], v[144:147], v[184:187]
v_mfma_f32_16x16x32_bf16 v[188:191], v[24:27], v[148:151], v[188:191]
v_mfma_f32_16x16x32_bf16 v[192:195], v[24:27], v[152:155], v[192:195]
v_mfma_f32_16x16x32_bf16 v[176:179], v[28:31], v[156:159], v[176:179]
v_mfma_f32_16x16x32_bf16 v[180:183], v[28:31], v[160:163], v[180:183]
v_mfma_f32_16x16x32_bf16 v[184:187], v[28:31], v[164:167], v[184:187]
v_mfma_f32_16x16x32_bf16 v[188:191], v[28:31], v[168:171], v[188:191]
v_mfma_f32_16x16x32_bf16 v[192:195], v[28:31], v[172:175], v[192:195]
v_and_b32 v12, 15, v1
v_bfe_u32 v13, v1, 4, 1
v_lshl_add_u32 v12, v12, 1, v13
v_lshlrev_b32 v12, 4, v12
s_mul_i32 s68, s3, 2560
v_add_u32 v12, s68, v12
s_mov_b32 exec_hi, 0
ds_write_b128 v12, v[176:179] offset:45056
ds_write_b128 v12, v[180:183] offset:45568
ds_write_b128 v12, v[184:187] offset:46080
ds_write_b128 v12, v[188:191] offset:46592
ds_write_b128 v12, v[192:195] offset:47104
s_mov_b64 exec, -1
s_waitcnt lgkmcnt(0)
s_barrier
v_lshlrev_b32 v12, 4, v0
s_cmp_lt_u32 s3, 3
s_cbranch_scc0 L_qend_35
ds_read_b128 v[32:35], v12 offset:45056
ds_read_b128 v[36:39], v12 offset:47616
ds_read_b128 v[40:43], v12 offset:50176
ds_read_b128 v[44:47], v12 offset:52736
ds_read_b128 v[48:51], v12 offset:55296
ds_read_b128 v[52:55], v12 offset:57856
ds_read_b128 v[56:59], v12 offset:60416
ds_read_b128 v[60:63], v12 offset:62976
s_mul_i32 s68, s4, 2560
s_add_u32 s68, s68, 458752
v_cmp_gt_u32 vcc, 160, v0
s_waitcnt lgkmcnt(0)
v_pk_add_f32 v[32:33], v[32:33], v[36:37]
v_pk_add_f32 v[34:35], v[34:35], v[38:39]
v_pk_add_f32 v[40:41], v[40:41], v[44:45]
v_pk_add_f32 v[42:43], v[42:43], v[46:47]
v_pk_add_f32 v[48:49], v[48:49], v[52:53]
v_pk_add_f32 v[50:51], v[50:51], v[54:55]
v_pk_add_f32 v[56:57], v[56:57], v[60:61]
v_pk_add_f32 v[58:59], v[58:59], v[62:63]
v_pk_add_f32 v[32:33], v[32:33], v[40:41]
v_pk_add_f32 v[34:35], v[34:35], v[42:43]
v_pk_add_f32 v[48:49], v[48:49], v[56:57]
v_pk_add_f32 v[50:51], v[50:51], v[58:59]
v_pk_add_f32 v[32:33], v[32:33], v[48:49]
v_pk_add_f32 v[34:35], v[34:35], v[50:51]
v_perm_b32 v32, v32, v35, s62
v_perm_b32 v33, v33, v35, s63
v_perm_b32 v34, v34, v35, s64
v_mov_b32 v35, v3
s_and_b64 exec, exec, vcc
buffer_store_dwordx4 v[32:35], v12, s[8:11], s68 offen sc1
s_mov_b64 exec, -1
L_qend_35:
s_endpgm
L_end:
s_endpgm
.section .rodata,"a"
.p2align 6
.amdhsa_kernel concat_heads__compressed_kv_cla__mha_block_cached__decode_kernel
  .amdhsa_next_free_vgpr 256
  .amdhsa_next_free_sgpr 102
  .amdhsa_accum_offset 256
  .amdhsa_group_segment_fixed_size 0
  .amdhsa_kernarg_size 112
  .amdhsa_user_sgpr_count 2
  .amdhsa_user_sgpr_kernarg_segment_ptr 1
  .amdhsa_system_sgpr_workgroup_id_x 1
  .amdhsa_float_denorm_mode_32 3
.end_amdhsa_kernel
```
